```python
import torch

def _softmax(x, axis=-1):
    return torch.softmax(x, dim=axis)
def _gelu(x):
    return torch.nn.functional.gelu(x, approximate="tanh")
def _silu(x):
    return torch.nn.functional.silu(x)
def _sigmoid(x):
    return torch.sigmoid(x)
def _layernorm(x, axis=-1, eps=1e-5):
    m = x.mean(dim=axis, keepdim=True)
    v = x.var(dim=axis, keepdim=True, unbiased=False)
    return (x - m) / torch.sqrt(v + eps)
def _scatter_add(tgt, idx, src, axis=0):
    return tgt.clone().index_add_(axis, idx, src)
def _segment_sum(src, seg, n):
    out = torch.zeros((n,) + src.shape[1:], dtype=src.dtype)
    return out.index_add_(0, seg, src)
def _pad(x, pw):
    flat = tuple(v for pair in reversed(pw) for v in pair)
    return torch.nn.functional.pad(x, flat)

kernel_name = 'gated_mix__ssm_conv_s4d__geglu_ffn__prompt'

def setup_inputs():

    _w = (lambda a: (lambda t: t.to(torch.bfloat16) if t.is_floating_point() else t)(torch.as_tensor(a)))
    def _A_setup():
        Bsz, L, D, N = 1, 2048, 512, 128
        return {
            "u": _w((lambda *s: torch.randn(*s, dtype=torch.bfloat16) * 0.05)(Bsz, L, D)),
            "log_A_real": _w((lambda *s: torch.randn(*s, dtype=torch.bfloat16) * 6.4)(D, N) * 0.5),
            "A_imag": _w((lambda *s: torch.randn(*s, dtype=torch.bfloat16) * 0.05)(D, N) * 3.14),
            "C_real": _w((lambda *s: torch.randn(*s, dtype=torch.bfloat16) * 0.05)(D, N) / N ** 0.5),
            "C_imag": _w((lambda *s: torch.randn(*s, dtype=torch.bfloat16) * 0.05)(D, N) / N ** 0.5),
            "log_dt": _w((lambda *s: torch.randn(*s, dtype=torch.bfloat16) * 0.05)(D) * 0.5 - 4.0),
            "D_skip": _w((lambda *s: torch.randn(*s, dtype=torch.bfloat16) * 0.05)(D)),
        }
    _A_in = _A_setup()

    def _B_setup():
        B, S, D, F = 1, 2048, 512, 1376
        return {
            "x": _w((lambda *s: torch.randn(*s, dtype=torch.bfloat16) * 0.05)(B, S, D)),
            "w_gate": _w((lambda *s: torch.randn(*s, dtype=torch.bfloat16) * 0.05)(D, F)),
            "w_up": _w((lambda *s: torch.randn(*s, dtype=torch.bfloat16) * 0.05)(D, F)),
            "w_down": _w((lambda *s: torch.randn(*s, dtype=torch.bfloat16) * 0.05)(F, D)),
        }
    _B_in = _B_setup()

    return {
        "A_u": _A_in["u"],
        "A_log_A_real": _A_in["log_A_real"],
        "A_A_imag": _A_in["A_imag"],
        "A_C_real": _A_in["C_real"],
        "A_C_imag": _A_in["C_imag"],
        "A_log_dt": _A_in["log_dt"],
        "A_D_skip": _A_in["D_skip"],
        "B_x": _B_in["x"],
        "B_w_gate": _B_in["w_gate"],
        "B_w_up": _B_in["w_up"],
        "B_w_down": _B_in["w_down"],
        "gate_w": _w((lambda *s: torch.randn(*s, dtype=torch.bfloat16) * 0.05)(512) * 16.0),
    }

def reference(A_u, A_log_A_real, A_A_imag, A_C_real, A_C_imag, A_log_dt, A_D_skip, B_x, B_w_gate, B_w_up, B_w_down, gate_w):
    def _A_ref(u, log_A_real, A_imag, C_real, C_imag, log_dt, D_skip):
        L = u.shape[1]
        dt = torch.exp(log_dt)
        A = -torch.exp(log_A_real) + 1j * A_imag
        C = (C_real + 1j * C_imag) * dt[:, None]
        pos = (lambda x, dt: x.to(dt))(torch.arange(L), log_dt.dtype)
        P = torch.exp((A * dt[:, None])[:, :, None] * pos[None, None, :])
        K = 2.0 * torch.einsum("dn,dnl->dl", C, P).real
        L2 = 2 * L
        u_t = (lambda x, *d: x.permute(*d))(u, 0, 2, 1)
        Kf = (lambda x, *a, **k: torch.fft.rfft(x.float(), *a, **k))(K, L2)
        Uf = (lambda x, *a, **k: torch.fft.rfft(x.float(), *a, **k))(u_t, L2)
        y = (lambda x, *a, **k: torch.fft.irfft(x, *a, **k).to(torch.bfloat16))(Uf * Kf[None, :, :], L2)[:, :, :L]
        y = (lambda x, *d: x.permute(*d))(y, 0, 2, 1)
        return y + u * D_skip[None, None, :]

    def _B_ref(x, w_gate, w_up, w_down):
        return (_gelu(x @ w_gate) * (x @ w_up)) @ w_down

    x = A_u
    g = _sigmoid((x * gate_w).sum(-1, keepdims=True))
    a = _A_ref(x, A_log_A_real, A_A_imag, A_C_real, A_C_imag, A_log_dt, A_D_skip)
    b = _B_ref(x, B_w_gate, B_w_up, B_w_down)
    return g * a + (1 - g) * b
```

```asm
; @launch kernel=k1_kernel grid=(512,1,1) block=(256,1,1) lds=81920
; @launch kernel=k2_kernel grid=(256,1,1) block=(256,1,1) lds=65536
.amdgcn_target "amdgcn-amd-amdhsa--gfx950"
.text
    .globl k1_kernel
    .type k1_kernel,@function
    .p2align 8
k1_kernel:
    s_cmp_ge_u32 s2, 512
    s_cbranch_scc1 K1_EXIT
    s_load_dwordx16 s[16:31], s[0:1], 0
    s_load_dwordx8 s[32:39], s[0:1], 64
    s_load_dwordx4 s[40:43], s[0:1], 96
    s_load_dwordx2 s[44:45], s[0:1], 112
    v_and_b32 v1, 63, v0
    v_lshrrev_b32 v2, 6, v0
    s_nop 0
    v_readfirstlane_b32 s49, v2
    s_waitcnt lgkmcnt(0)
    s_mov_b32 s3, s2
    s_cmp_lt_u32 s2, 256
    s_cbranch_scc1 CONV
    s_sub_u32 s46, s2, 256
    s_and_b32 s46, s46, 0xC6
    s_cmp_eq_u32 s46, 0xC6
    s_cbranch_scc1 AUX_J
    s_branch G1_J
AUX_J:
    s_branch AUX
G1_J:
    s_branch G1
K1_EXIT:
    s_endpgm
CONV:
    s_and_b32 s46, s3, 7
    s_lshl_b32 s46, s46, 5
    s_lshr_b32 s47, s3, 3
    s_add_u32 s46, s46, s47
    s_lshr_b32 s90, s49, 1
    s_and_b32 s91, s49, 1
    s_lshl_b32 s47, s46, 1
    s_add_u32 s47, s47, s90
    s_mov_b32 s52, s16
    s_mov_b32 s53, s17
    s_and_b32 s53, s53, 0xffff
    s_mov_b32 s54, 2097152
    s_mov_b32 s55, 0x00020000
    s_mov_b32 s56, s18
    s_mov_b32 s57, s19
    s_and_b32 s57, s57, 0xffff
    s_mov_b32 s58, 131072
    s_mov_b32 s59, 0x00020000
    s_mov_b32 s60, s20
    s_mov_b32 s61, s21
    s_and_b32 s61, s61, 0xffff
    s_mov_b32 s62, 131072
    s_mov_b32 s63, 0x00020000
    s_mov_b32 s64, s22
    s_mov_b32 s65, s23
    s_and_b32 s65, s65, 0xffff
    s_mov_b32 s66, 131072
    s_mov_b32 s67, 0x00020000
    s_mov_b32 s68, s24
    s_mov_b32 s69, s25
    s_and_b32 s69, s69, 0xffff
    s_mov_b32 s70, 131072
    s_mov_b32 s71, 0x00020000
    s_add_u32 s72, s44, 8388608
    s_addc_u32 s73, s45, 0
    s_and_b32 s73, s73, 0xffff
    s_mov_b32 s74, 2097152
    s_mov_b32 s75, 0x00020000
    s_lshl_b32 s48, s46, 2
    s_add_u32 s76, s26, s48
    s_addc_u32 s77, s27, 0
    s_add_u32 s78, s28, s48
    s_addc_u32 s79, s29, 0
    s_load_dword s80, s[76:77], 0
    s_load_dword s81, s[78:79], 0
    v_lshlrev_b32 v2, 10, v0
    v_add_u32 v2, s48, v2
    s_lshl_b32 s48, s47, 8
    v_lshlrev_b32 v3, 2, v1
    v_add_u32 v3, s48, v3
    buffer_load_dword v24, v3, s[56:59], 0 offen
    buffer_load_dword v25, v3, s[60:63], 0 offen
    buffer_load_dword v26, v3, s[64:67], 0 offen
    buffer_load_dword v27, v3, s[68:71], 0 offen
    s_mov_b32 s56, s38
    s_mov_b32 s57, s39
    s_and_b32 s57, s57, 0xffff
    s_mov_b32 s58, 1024
    s_mov_b32 s59, 0x00020000
    v_lshlrev_b32 v3, 4, v1
    s_lshl_b32 s48, s3, 2
    s_add_u32 s48, s48, s49
    s_lshl_b32 s48, s48, 11
    buffer_load_dwordx4 v[120:123], v3, s[56:59], 0 offen
    buffer_load_dwordx4 v[124:127], v3, s[52:55], s48 offen
    buffer_load_dwordx4 v[128:131], v3, s[52:55], s48 offen offset:1024
    s_mul_i32 s92, s90, 33152
    s_mul_i32 s93, s90, 7680
    s_add_u32 s93, s93, 66304
    s_mul_i32 s50, s91, 1280
    s_add_u32 s50, s50, s93
    v_lshlrev_b32 v4, 4, v1
    v_add_u32 v4, s50, v4
    v_mov_b32 v28, 0
    v_mov_b32 v29, 0
    v_mov_b32 v30, 0
    v_mov_b32 v31, 0
    ds_write_b128 v4, v[28:31]
    v_cmp_gt_u32 vcc, 16, v1
    s_nop 0
    s_and_saveexec_b64 s[82:83], vcc
    ds_write_b128 v4, v[28:31] offset:1024
    s_mov_b64 exec, s[82:83]
    s_lshl_b32 s50, s91, 10
    v_lshlrev_b32 v5, 3, v1
    v_add_u32 v5, s50, v5
    v_sub_u32 v5, 2047, v5
    s_movk_i32 s48, 17024
    s_add_u32 s51, s92, 4096
    v_subrev_u32 v6, 0, v5
    v_cvt_f32_u32 v7, v6
    v_cvt_pk_bf16_f32 v7, v7, v7
    v_and_b32 v7, 0xffff, v7
    v_subrev_u32 v7, s48, v7
    v_cmp_gt_u32 vcc, 128, v6
    s_nop 1
    v_cndmask_b32 v96, v7, v6, vcc
    v_lshl_add_u32 v96, v96, 2, s51
    v_subrev_u32 v6, 1, v5
    v_cvt_f32_u32 v7, v6
    v_cvt_pk_bf16_f32 v7, v7, v7
    v_and_b32 v7, 0xffff, v7
    v_subrev_u32 v7, s48, v7
    v_cmp_gt_u32 vcc, 128, v6
    s_nop 1
    v_cndmask_b32 v97, v7, v6, vcc
    v_lshl_add_u32 v97, v97, 2, s51
    v_subrev_u32 v6, 2, v5
    v_cvt_f32_u32 v7, v6
    v_cvt_pk_bf16_f32 v7, v7, v7
    v_and_b32 v7, 0xffff, v7
    v_subrev_u32 v7, s48, v7
    v_cmp_gt_u32 vcc, 128, v6
    s_nop 1
    v_cndmask_b32 v98, v7, v6, vcc
    v_lshl_add_u32 v98, v98, 2, s51
    v_subrev_u32 v6, 3, v5
    v_cvt_f32_u32 v7, v6
    v_cvt_pk_bf16_f32 v7, v7, v7
    v_and_b32 v7, 0xffff, v7
    v_subrev_u32 v7, s48, v7
    v_cmp_gt_u32 vcc, 128, v6
    s_nop 1
    v_cndmask_b32 v99, v7, v6, vcc
    v_lshl_add_u32 v99, v99, 2, s51
    v_subrev_u32 v6, 4, v5
    v_cvt_f32_u32 v7, v6
    v_cvt_pk_bf16_f32 v7, v7, v7
    v_and_b32 v7, 0xffff, v7
    v_subrev_u32 v7, s48, v7
    v_cmp_gt_u32 vcc, 128, v6
    s_nop 1
    v_cndmask_b32 v100, v7, v6, vcc
    v_lshl_add_u32 v100, v100, 2, s51
    v_subrev_u32 v6, 5, v5
    v_cvt_f32_u32 v7, v6
    v_cvt_pk_bf16_f32 v7, v7, v7
    v_and_b32 v7, 0xffff, v7
    v_subrev_u32 v7, s48, v7
    v_cmp_gt_u32 vcc, 128, v6
    s_nop 1
    v_cndmask_b32 v101, v7, v6, vcc
    v_lshl_add_u32 v101, v101, 2, s51
    v_subrev_u32 v6, 6, v5
    v_cvt_f32_u32 v7, v6
    v_cvt_pk_bf16_f32 v7, v7, v7
    v_and_b32 v7, 0xffff, v7
    v_subrev_u32 v7, s48, v7
    v_cmp_gt_u32 vcc, 128, v6
    s_nop 1
    v_cndmask_b32 v102, v7, v6, vcc
    v_lshl_add_u32 v102, v102, 2, s51
    v_subrev_u32 v6, 7, v5
    v_cvt_f32_u32 v7, v6
    v_cvt_pk_bf16_f32 v7, v7, v7
    v_and_b32 v7, 0xffff, v7
    v_subrev_u32 v7, s48, v7
    v_cmp_gt_u32 vcc, 128, v6
    s_nop 1
    v_cndmask_b32 v103, v7, v6, vcc
    v_lshl_add_u32 v103, v103, 2, s51
    v_subrev_u32 v6, 512, v5
    v_cvt_f32_u32 v7, v6
    v_cvt_pk_bf16_f32 v7, v7, v7
    v_and_b32 v7, 0xffff, v7
    v_subrev_u32 v7, s48, v7
    v_cmp_gt_u32 vcc, 128, v6
    s_nop 1
    v_cndmask_b32 v104, v7, v6, vcc
    v_lshl_add_u32 v104, v104, 2, s51
    v_subrev_u32 v6, 513, v5
    v_cvt_f32_u32 v7, v6
    v_cvt_pk_bf16_f32 v7, v7, v7
    v_and_b32 v7, 0xffff, v7
    v_subrev_u32 v7, s48, v7
    v_cmp_gt_u32 vcc, 128, v6
    s_nop 1
    v_cndmask_b32 v105, v7, v6, vcc
    v_lshl_add_u32 v105, v105, 2, s51
    v_subrev_u32 v6, 514, v5
    v_cvt_f32_u32 v7, v6
    v_cvt_pk_bf16_f32 v7, v7, v7
    v_and_b32 v7, 0xffff, v7
    v_subrev_u32 v7, s48, v7
    v_cmp_gt_u32 vcc, 128, v6
    s_nop 1
    v_cndmask_b32 v106, v7, v6, vcc
    v_lshl_add_u32 v106, v106, 2, s51
    v_subrev_u32 v6, 515, v5
    v_cvt_f32_u32 v7, v6
    v_cvt_pk_bf16_f32 v7, v7, v7
    v_and_b32 v7, 0xffff, v7
    v_subrev_u32 v7, s48, v7
    v_cmp_gt_u32 vcc, 128, v6
    s_nop 1
    v_cndmask_b32 v107, v7, v6, vcc
    v_lshl_add_u32 v107, v107, 2, s51
    v_subrev_u32 v6, 516, v5
    v_cvt_f32_u32 v7, v6
    v_cvt_pk_bf16_f32 v7, v7, v7
    v_and_b32 v7, 0xffff, v7
    v_subrev_u32 v7, s48, v7
    v_cmp_gt_u32 vcc, 128, v6
    s_nop 1
    v_cndmask_b32 v108, v7, v6, vcc
    v_lshl_add_u32 v108, v108, 2, s51
    v_subrev_u32 v6, 517, v5
    v_cvt_f32_u32 v7, v6
    v_cvt_pk_bf16_f32 v7, v7, v7
    v_and_b32 v7, 0xffff, v7
    v_subrev_u32 v7, s48, v7
    v_cmp_gt_u32 vcc, 128, v6
    s_nop 1
    v_cndmask_b32 v109, v7, v6, vcc
    v_lshl_add_u32 v109, v109, 2, s51
    v_subrev_u32 v6, 518, v5
    v_cvt_f32_u32 v7, v6
    v_cvt_pk_bf16_f32 v7, v7, v7
    v_and_b32 v7, 0xffff, v7
    v_subrev_u32 v7, s48, v7
    v_cmp_gt_u32 vcc, 128, v6
    s_nop 1
    v_cndmask_b32 v110, v7, v6, vcc
    v_lshl_add_u32 v110, v110, 2, s51
    v_subrev_u32 v6, 519, v5
    v_cvt_f32_u32 v7, v6
    v_cvt_pk_bf16_f32 v7, v7, v7
    v_and_b32 v7, 0xffff, v7
    v_subrev_u32 v7, s48, v7
    v_cmp_gt_u32 vcc, 128, v6
    s_nop 1
    v_cndmask_b32 v111, v7, v6, vcc
    v_lshl_add_u32 v111, v111, 2, s51
    s_waitcnt vmcnt(3) lgkmcnt(0)
    s_cmp_eq_u32 s90, 1
    s_cselect_b32 s48, 0, 16
    s_lshl_b32 s80, s80, s48
    s_and_b32 s80, s80, 0xffff0000
    s_lshl_b32 s81, s81, s48
    s_and_b32 s81, s81, 0xffff0000
    v_mov_b32 v28, s80
    v_mul_f32 v28, 0x3fb8aa3b, v28
    v_exp_f32 v28, v28
    s_nop 0
    v_cvt_pk_bf16_f32 v28, v28, v28
    v_lshlrev_b32 v28, 16, v28
    v_lshlrev_b32 v32, 16, v24
    v_and_b32 v33, 0xffff0000, v24
    v_lshlrev_b32 v34, 16, v25
    v_and_b32 v35, 0xffff0000, v25
    v_lshlrev_b32 v36, 16, v26
    v_and_b32 v37, 0xffff0000, v26
    v_lshlrev_b32 v38, 16, v27
    v_and_b32 v39, 0xffff0000, v27
    v_max3_f32 v40, |v36|, |v37|, |v38|
    v_max_f32 v40, |v39|, v40
    s_nop 1
    v_max_f32_dpp v40, v40, v40 row_shr:1 row_mask:0xf bank_mask:0xf bound_ctrl:0
    s_nop 1
    v_max_f32_dpp v40, v40, v40 row_shr:2 row_mask:0xf bank_mask:0xf bound_ctrl:0
    s_nop 1
    v_max_f32_dpp v40, v40, v40 row_shr:4 row_mask:0xf bank_mask:0xf bound_ctrl:0
    s_nop 1
    v_max_f32_dpp v40, v40, v40 row_shr:8 row_mask:0xf bank_mask:0xf bound_ctrl:0
    s_nop 1
    v_max_f32_dpp v40, v40, v40 row_bcast:15 row_mask:0xa bank_mask:0xf
    s_nop 1
    v_max_f32_dpp v40, v40, v40 row_bcast:31 row_mask:0xc bank_mask:0xf
    s_nop 0
    v_readlane_b32 s50, v40, 63
    s_nop 1
    v_mov_b32 v40, s50
    v_cmp_eq_f32 vcc, 0, v40
    s_nop 1
    v_cndmask_b32 v40, v40, 1.0, vcc
    v_rcp_f32 v41, v40
    v_mul_f32 v42, v40, v28
    v_add_f32 v42, v42, v42
    v_mul_f32 v32, 0x3fb8aa3b, v32
    v_exp_f32 v32, v32
    s_nop 0
    v_cvt_pk_bf16_f32 v32, v32, v32
    v_lshlrev_b32 v32, 16, v32
    v_mul_f32 v32, v32, v28
    v_mul_f32 v44, 0xbfb8aa3b, v32
    v_mul_f32 v34, v34, v28
    v_mul_f32 v45, 0x3e22f983, v34
    v_mul_f32 v46, v36, v41
    v_mul_f32 v47, v38, v41
    v_mul_f32 v33, 0x3fb8aa3b, v33
    v_exp_f32 v33, v33
    s_nop 0
    v_cvt_pk_bf16_f32 v33, v33, v33
    v_lshlrev_b32 v33, 16, v33
    v_mul_f32 v33, v33, v28
    v_mul_f32 v48, 0xbfb8aa3b, v33
    v_mul_f32 v35, v35, v28
    v_mul_f32 v49, 0x3e22f983, v35
    v_mul_f32 v50, v37, v41
    v_mul_f32 v51, v39, v41
    s_lshl_b32 s50, s91, 11
    s_add_u32 s50, s50, s92
    v_lshlrev_b32 v4, 5, v1
    v_add_u32 v4, s50, v4
    ds_write_b128 v4, v[44:47]
    ds_write_b128 v4, v[48:51] offset:16
    v_mul_f32 v8, 0x45000000, v44
    v_mul_f32 v9, 0x45000000, v45
    v_exp_f32 v8, v8
    v_fract_f32 v9, v9
    v_cos_f32 v10, v9
    v_sin_f32 v11, v9
    v_mul_f32 v10, v10, v46
    v_fma_f32 v10, -v11, v47, v10
    v_mul_f32 v52, v10, v8
    v_mul_f32 v8, 0x45000000, v48
    v_mul_f32 v9, 0x45000000, v49
    v_exp_f32 v8, v8
    v_fract_f32 v9, v9
    v_cos_f32 v10, v9
    v_sin_f32 v11, v9
    v_mul_f32 v10, v10, v50
    v_fma_f32 v10, -v11, v51, v10
    v_mul_f32 v53, v10, v8
    v_add_f32 v52, v52, v53
    s_nop 1
    v_add_f32_dpp v52, v52, v52 row_shr:1 row_mask:0xf bank_mask:0xf bound_ctrl:0
    s_nop 1
    v_add_f32_dpp v52, v52, v52 row_shr:2 row_mask:0xf bank_mask:0xf bound_ctrl:0
    s_nop 1
    v_add_f32_dpp v52, v52, v52 row_shr:4 row_mask:0xf bank_mask:0xf bound_ctrl:0
    s_nop 1
    v_add_f32_dpp v52, v52, v52 row_shr:8 row_mask:0xf bank_mask:0xf bound_ctrl:0
    s_nop 1
    v_add_f32_dpp v52, v52, v52 row_bcast:15 row_mask:0xa bank_mask:0xf
    s_nop 1
    v_add_f32_dpp v52, v52, v52 row_bcast:31 row_mask:0xc bank_mask:0xf
    s_nop 0
    v_readlane_b32 s94, v52, 63
    s_cmp_eq_u32 s91, 0
    s_cselect_b32 s94, s94, 0
    s_lshl_b32 s48, s91, 10
    s_add_u32 s48, s48, s50
    v_lshrrev_b32 v4, 4, v1
    v_lshlrev_b32 v4, 6, v4
    v_add_u32 v4, s48, v4
    v_and_b32 v5, 15, v1
    v_cvt_f32_u32 v6, v5
    s_waitcnt lgkmcnt(0)
    v_mov_b32 v192, 0
    v_mov_b32 v193, 0
    v_mov_b32 v194, 0
    v_mov_b32 v195, 0
    v_mov_b32 v196, 0
    v_mov_b32 v197, 0
    v_mov_b32 v198, 0
    v_mov_b32 v199, 0
    v_mov_b32 v200, 0
    v_mov_b32 v201, 0
    v_mov_b32 v202, 0
    v_mov_b32 v203, 0
    v_mov_b32 v204, 0
    v_mov_b32 v205, 0
    v_mov_b32 v206, 0
    v_mov_b32 v207, 0
    ds_read_b128 v[48:51], v4 offset:0
    ds_read_b128 v[52:55], v4 offset:16
    ds_read_b128 v[56:59], v4 offset:32
    ds_read_b128 v[60:63], v4 offset:48
    s_mov_b32 s95, 0
KG_LOOP:
    s_nop 1
    s_waitcnt lgkmcnt(2)
    v_mul_f32 v12, v48, v6
    v_mul_f32 v18, v52, v6
    v_mul_f32 v13, v49, v6
    v_mul_f32 v19, v53, v6
    v_exp_f32 v12, v12
    v_exp_f32 v18, v18
    v_fract_f32 v13, v13
    v_fract_f32 v19, v19
    v_cos_f32 v8, v13
    v_cos_f32 v14, v19
    v_sin_f32 v9, v13
    v_sin_f32 v15, v19
    v_pk_mul_f32 v[8:9], v[8:9], v[12:13] op_sel_hi:[1,0]
    v_pk_mul_f32 v[14:15], v[14:15], v[18:19] op_sel_hi:[1,0]
    v_cvt_pk_f16_f32 v64, v8, v9
    v_cvt_pk_f16_f32 v65, v14, v15
    v_pk_mul_f32 v[10:11], v[8:9], v[8:9] op_sel:[0,0] op_sel_hi:[0,1]
    v_pk_mul_f32 v[16:17], v[14:15], v[14:15] op_sel:[0,0] op_sel_hi:[0,1]
    v_pk_fma_f32 v[8:9], v[8:9], v[8:9], v[10:11] op_sel:[1,1,0] op_sel_hi:[0,1,1] neg_lo:[1,0,0]
    v_pk_fma_f32 v[14:15], v[14:15], v[14:15], v[16:17] op_sel:[1,1,0] op_sel_hi:[0,1,1] neg_lo:[1,0,0]
    v_cvt_pk_f16_f32 v68, v8, v9
    v_cvt_pk_f16_f32 v69, v14, v15
    v_pk_mul_f32 v[10:11], v[8:9], v[8:9] op_sel:[0,0] op_sel_hi:[0,1]
    v_pk_mul_f32 v[16:17], v[14:15], v[14:15] op_sel:[0,0] op_sel_hi:[0,1]
    v_pk_fma_f32 v[8:9], v[8:9], v[8:9], v[10:11] op_sel:[1,1,0] op_sel_hi:[0,1,1] neg_lo:[1,0,0]
    v_pk_fma_f32 v[14:15], v[14:15], v[14:15], v[16:17] op_sel:[1,1,0] op_sel_hi:[0,1,1] neg_lo:[1,0,0]
    v_cvt_pk_f16_f32 v72, v8, v9
    v_cvt_pk_f16_f32 v73, v14, v15
    v_pk_mul_f32 v[10:11], v[8:9], v[8:9] op_sel:[0,0] op_sel_hi:[0,1]
    v_pk_mul_f32 v[16:17], v[14:15], v[14:15] op_sel:[0,0] op_sel_hi:[0,1]
    v_pk_fma_f32 v[8:9], v[8:9], v[8:9], v[10:11] op_sel:[1,1,0] op_sel_hi:[0,1,1] neg_lo:[1,0,0]
    v_pk_fma_f32 v[14:15], v[14:15], v[14:15], v[16:17] op_sel:[1,1,0] op_sel_hi:[0,1,1] neg_lo:[1,0,0]
    v_cvt_pk_f16_f32 v76, v8, v9
    v_cvt_pk_f16_f32 v77, v14, v15
    v_pk_mul_f32 v[10:11], v[8:9], v[8:9] op_sel:[0,0] op_sel_hi:[0,1]
    v_pk_mul_f32 v[16:17], v[14:15], v[14:15] op_sel:[0,0] op_sel_hi:[0,1]
    v_pk_fma_f32 v[8:9], v[8:9], v[8:9], v[10:11] op_sel:[1,1,0] op_sel_hi:[0,1,1] neg_lo:[1,0,0]
    v_pk_fma_f32 v[14:15], v[14:15], v[14:15], v[16:17] op_sel:[1,1,0] op_sel_hi:[0,1,1] neg_lo:[1,0,0]
    v_pk_mul_f32 v[12:13], v[50:51], v[8:9] op_sel:[0,0] op_sel_hi:[0,1]
    v_pk_mul_f32 v[18:19], v[54:55], v[14:15] op_sel:[0,0] op_sel_hi:[0,1]
    v_pk_fma_f32 v[12:13], v[50:51], v[8:9], v[12:13] op_sel:[1,1,0] op_sel_hi:[1,0,1] neg_lo:[1,0,0] neg_hi:[1,0,1]
    v_pk_fma_f32 v[18:19], v[54:55], v[14:15], v[18:19] op_sel:[1,1,0] op_sel_hi:[1,0,1] neg_lo:[1,0,0] neg_hi:[1,0,1]
    v_pk_mul_f32 v[10:11], v[8:9], v[8:9] op_sel:[0,0] op_sel_hi:[0,1]
    v_pk_mul_f32 v[16:17], v[14:15], v[14:15] op_sel:[0,0] op_sel_hi:[0,1]
    v_pk_fma_f32 v[8:9], v[8:9], v[8:9], v[10:11] op_sel:[1,1,0] op_sel_hi:[0,1,1] neg_lo:[1,0,0]
    v_pk_fma_f32 v[14:15], v[14:15], v[14:15], v[16:17] op_sel:[1,1,0] op_sel_hi:[0,1,1] neg_lo:[1,0,0]
    v_cvt_pk_f16_f32 v80, v12, v13
    v_cvt_pk_f16_f32 v81, v18, v19
    v_pk_mul_f32 v[12:13], v[50:51], v[8:9] op_sel:[0,0] op_sel_hi:[0,1]
    v_pk_mul_f32 v[18:19], v[54:55], v[14:15] op_sel:[0,0] op_sel_hi:[0,1]
    v_pk_fma_f32 v[12:13], v[50:51], v[8:9], v[12:13] op_sel:[1,1,0] op_sel_hi:[1,0,1] neg_lo:[1,0,0] neg_hi:[1,0,1]
    v_pk_fma_f32 v[18:19], v[54:55], v[14:15], v[18:19] op_sel:[1,1,0] op_sel_hi:[1,0,1] neg_lo:[1,0,0] neg_hi:[1,0,1]
    v_pk_mul_f32 v[10:11], v[8:9], v[8:9] op_sel:[0,0] op_sel_hi:[0,1]
    v_pk_mul_f32 v[16:17], v[14:15], v[14:15] op_sel:[0,0] op_sel_hi:[0,1]
    v_pk_fma_f32 v[8:9], v[8:9], v[8:9], v[10:11] op_sel:[1,1,0] op_sel_hi:[0,1,1] neg_lo:[1,0,0]
    v_pk_fma_f32 v[14:15], v[14:15], v[14:15], v[16:17] op_sel:[1,1,0] op_sel_hi:[0,1,1] neg_lo:[1,0,0]
    v_cvt_pk_f16_f32 v84, v12, v13
    v_cvt_pk_f16_f32 v85, v18, v19
    v_pk_mul_f32 v[12:13], v[50:51], v[8:9] op_sel:[0,0] op_sel_hi:[0,1]
    v_pk_mul_f32 v[18:19], v[54:55], v[14:15] op_sel:[0,0] op_sel_hi:[0,1]
    v_pk_fma_f32 v[12:13], v[50:51], v[8:9], v[12:13] op_sel:[1,1,0] op_sel_hi:[1,0,1] neg_lo:[1,0,0] neg_hi:[1,0,1]
    v_pk_fma_f32 v[18:19], v[54:55], v[14:15], v[18:19] op_sel:[1,1,0] op_sel_hi:[1,0,1] neg_lo:[1,0,0] neg_hi:[1,0,1]
    v_pk_mul_f32 v[10:11], v[8:9], v[8:9] op_sel:[0,0] op_sel_hi:[0,1]
    v_pk_mul_f32 v[16:17], v[14:15], v[14:15] op_sel:[0,0] op_sel_hi:[0,1]
    v_pk_fma_f32 v[8:9], v[8:9], v[8:9], v[10:11] op_sel:[1,1,0] op_sel_hi:[0,1,1] neg_lo:[1,0,0]
    v_pk_fma_f32 v[14:15], v[14:15], v[14:15], v[16:17] op_sel:[1,1,0] op_sel_hi:[0,1,1] neg_lo:[1,0,0]
    v_cvt_pk_f16_f32 v88, v12, v13
    v_cvt_pk_f16_f32 v89, v18, v19
    v_pk_mul_f32 v[12:13], v[50:51], v[8:9] op_sel:[0,0] op_sel_hi:[0,1]
    v_pk_mul_f32 v[18:19], v[54:55], v[14:15] op_sel:[0,0] op_sel_hi:[0,1]
    v_pk_fma_f32 v[12:13], v[50:51], v[8:9], v[12:13] op_sel:[1,1,0] op_sel_hi:[1,0,1] neg_lo:[1,0,0] neg_hi:[1,0,1]
    v_pk_fma_f32 v[18:19], v[54:55], v[14:15], v[18:19] op_sel:[1,1,0] op_sel_hi:[1,0,1] neg_lo:[1,0,0] neg_hi:[1,0,1]
    v_cvt_pk_f16_f32 v92, v12, v13
    v_cvt_pk_f16_f32 v93, v18, v19
    ds_read_b128 v[48:51], v4 offset:256
    ds_read_b128 v[52:55], v4 offset:272
    s_waitcnt lgkmcnt(2)
    v_mul_f32 v12, v56, v6
    v_mul_f32 v18, v60, v6
    v_mul_f32 v13, v57, v6
    v_mul_f32 v19, v61, v6
    v_exp_f32 v12, v12
    v_exp_f32 v18, v18
    v_fract_f32 v13, v13
    v_fract_f32 v19, v19
    v_cos_f32 v8, v13
    v_cos_f32 v14, v19
    v_sin_f32 v9, v13
    v_sin_f32 v15, v19
    v_pk_mul_f32 v[8:9], v[8:9], v[12:13] op_sel_hi:[1,0]
    v_pk_mul_f32 v[14:15], v[14:15], v[18:19] op_sel_hi:[1,0]
    v_cvt_pk_f16_f32 v66, v8, v9
    v_cvt_pk_f16_f32 v67, v14, v15
    v_pk_mul_f32 v[10:11], v[8:9], v[8:9] op_sel:[0,0] op_sel_hi:[0,1]
    v_pk_mul_f32 v[16:17], v[14:15], v[14:15] op_sel:[0,0] op_sel_hi:[0,1]
    v_pk_fma_f32 v[8:9], v[8:9], v[8:9], v[10:11] op_sel:[1,1,0] op_sel_hi:[0,1,1] neg_lo:[1,0,0]
    v_pk_fma_f32 v[14:15], v[14:15], v[14:15], v[16:17] op_sel:[1,1,0] op_sel_hi:[0,1,1] neg_lo:[1,0,0]
    v_cvt_pk_f16_f32 v70, v8, v9
    v_cvt_pk_f16_f32 v71, v14, v15
    v_pk_mul_f32 v[10:11], v[8:9], v[8:9] op_sel:[0,0] op_sel_hi:[0,1]
    v_pk_mul_f32 v[16:17], v[14:15], v[14:15] op_sel:[0,0] op_sel_hi:[0,1]
    v_pk_fma_f32 v[8:9], v[8:9], v[8:9], v[10:11] op_sel:[1,1,0] op_sel_hi:[0,1,1] neg_lo:[1,0,0]
    v_pk_fma_f32 v[14:15], v[14:15], v[14:15], v[16:17] op_sel:[1,1,0] op_sel_hi:[0,1,1] neg_lo:[1,0,0]
    v_cvt_pk_f16_f32 v74, v8, v9
    v_cvt_pk_f16_f32 v75, v14, v15
    v_pk_mul_f32 v[10:11], v[8:9], v[8:9] op_sel:[0,0] op_sel_hi:[0,1]
    v_pk_mul_f32 v[16:17], v[14:15], v[14:15] op_sel:[0,0] op_sel_hi:[0,1]
    v_pk_fma_f32 v[8:9], v[8:9], v[8:9], v[10:11] op_sel:[1,1,0] op_sel_hi:[0,1,1] neg_lo:[1,0,0]
    v_pk_fma_f32 v[14:15], v[14:15], v[14:15], v[16:17] op_sel:[1,1,0] op_sel_hi:[0,1,1] neg_lo:[1,0,0]
    v_cvt_pk_f16_f32 v78, v8, v9
    v_cvt_pk_f16_f32 v79, v14, v15
    v_pk_mul_f32 v[10:11], v[8:9], v[8:9] op_sel:[0,0] op_sel_hi:[0,1]
    v_pk_mul_f32 v[16:17], v[14:15], v[14:15] op_sel:[0,0] op_sel_hi:[0,1]
    v_pk_fma_f32 v[8:9], v[8:9], v[8:9], v[10:11] op_sel:[1,1,0] op_sel_hi:[0,1,1] neg_lo:[1,0,0]
    v_pk_fma_f32 v[14:15], v[14:15], v[14:15], v[16:17] op_sel:[1,1,0] op_sel_hi:[0,1,1] neg_lo:[1,0,0]
    v_pk_mul_f32 v[12:13], v[58:59], v[8:9] op_sel:[0,0] op_sel_hi:[0,1]
    v_pk_mul_f32 v[18:19], v[62:63], v[14:15] op_sel:[0,0] op_sel_hi:[0,1]
    v_pk_fma_f32 v[12:13], v[58:59], v[8:9], v[12:13] op_sel:[1,1,0] op_sel_hi:[1,0,1] neg_lo:[1,0,0] neg_hi:[1,0,1]
    v_pk_fma_f32 v[18:19], v[62:63], v[14:15], v[18:19] op_sel:[1,1,0] op_sel_hi:[1,0,1] neg_lo:[1,0,0] neg_hi:[1,0,1]
    v_pk_mul_f32 v[10:11], v[8:9], v[8:9] op_sel:[0,0] op_sel_hi:[0,1]
    v_pk_mul_f32 v[16:17], v[14:15], v[14:15] op_sel:[0,0] op_sel_hi:[0,1]
    v_pk_fma_f32 v[8:9], v[8:9], v[8:9], v[10:11] op_sel:[1,1,0] op_sel_hi:[0,1,1] neg_lo:[1,0,0]
    v_pk_fma_f32 v[14:15], v[14:15], v[14:15], v[16:17] op_sel:[1,1,0] op_sel_hi:[0,1,1] neg_lo:[1,0,0]
    v_cvt_pk_f16_f32 v82, v12, v13
    v_cvt_pk_f16_f32 v83, v18, v19
    v_pk_mul_f32 v[12:13], v[58:59], v[8:9] op_sel:[0,0] op_sel_hi:[0,1]
    v_pk_mul_f32 v[18:19], v[62:63], v[14:15] op_sel:[0,0] op_sel_hi:[0,1]
    v_pk_fma_f32 v[12:13], v[58:59], v[8:9], v[12:13] op_sel:[1,1,0] op_sel_hi:[1,0,1] neg_lo:[1,0,0] neg_hi:[1,0,1]
    v_pk_fma_f32 v[18:19], v[62:63], v[14:15], v[18:19] op_sel:[1,1,0] op_sel_hi:[1,0,1] neg_lo:[1,0,0] neg_hi:[1,0,1]
    v_pk_mul_f32 v[10:11], v[8:9], v[8:9] op_sel:[0,0] op_sel_hi:[0,1]
    v_pk_mul_f32 v[16:17], v[14:15], v[14:15] op_sel:[0,0] op_sel_hi:[0,1]
    v_pk_fma_f32 v[8:9], v[8:9], v[8:9], v[10:11] op_sel:[1,1,0] op_sel_hi:[0,1,1] neg_lo:[1,0,0]
    v_pk_fma_f32 v[14:15], v[14:15], v[14:15], v[16:17] op_sel:[1,1,0] op_sel_hi:[0,1,1] neg_lo:[1,0,0]
    v_cvt_pk_f16_f32 v86, v12, v13
    v_cvt_pk_f16_f32 v87, v18, v19
    v_pk_mul_f32 v[12:13], v[58:59], v[8:9] op_sel:[0,0] op_sel_hi:[0,1]
    v_pk_mul_f32 v[18:19], v[62:63], v[14:15] op_sel:[0,0] op_sel_hi:[0,1]
    v_pk_fma_f32 v[12:13], v[58:59], v[8:9], v[12:13] op_sel:[1,1,0] op_sel_hi:[1,0,1] neg_lo:[1,0,0] neg_hi:[1,0,1]
    v_pk_fma_f32 v[18:19], v[62:63], v[14:15], v[18:19] op_sel:[1,1,0] op_sel_hi:[1,0,1] neg_lo:[1,0,0] neg_hi:[1,0,1]
    v_pk_mul_f32 v[10:11], v[8:9], v[8:9] op_sel:[0,0] op_sel_hi:[0,1]
    v_pk_mul_f32 v[16:17], v[14:15], v[14:15] op_sel:[0,0] op_sel_hi:[0,1]
    v_pk_fma_f32 v[8:9], v[8:9], v[8:9], v[10:11] op_sel:[1,1,0] op_sel_hi:[0,1,1] neg_lo:[1,0,0]
    v_pk_fma_f32 v[14:15], v[14:15], v[14:15], v[16:17] op_sel:[1,1,0] op_sel_hi:[0,1,1] neg_lo:[1,0,0]
    v_cvt_pk_f16_f32 v90, v12, v13
    v_cvt_pk_f16_f32 v91, v18, v19
    v_pk_mul_f32 v[12:13], v[58:59], v[8:9] op_sel:[0,0] op_sel_hi:[0,1]
    v_pk_mul_f32 v[18:19], v[62:63], v[14:15] op_sel:[0,0] op_sel_hi:[0,1]
    v_pk_fma_f32 v[12:13], v[58:59], v[8:9], v[12:13] op_sel:[1,1,0] op_sel_hi:[1,0,1] neg_lo:[1,0,0] neg_hi:[1,0,1]
    v_pk_fma_f32 v[18:19], v[62:63], v[14:15], v[18:19] op_sel:[1,1,0] op_sel_hi:[1,0,1] neg_lo:[1,0,0] neg_hi:[1,0,1]
    v_cvt_pk_f16_f32 v94, v12, v13
    v_cvt_pk_f16_f32 v95, v18, v19
    ds_read_b128 v[56:59], v4 offset:288
    ds_read_b128 v[60:63], v4 offset:304
    v_mfma_f32_16x16x32_f16 v[192:195], v[80:83], v[64:67], v[192:195]
    v_mfma_f32_16x16x32_f16 v[196:199], v[84:87], v[68:71], v[196:199]
    v_mfma_f32_16x16x32_f16 v[200:203], v[88:91], v[72:75], v[200:203]
    v_mfma_f32_16x16x32_f16 v[204:207], v[92:95], v[76:79], v[204:207]
    v_add_u32 v4, 256, v4
    s_add_u32 s95, s95, 1
    s_cmp_lt_u32 s95, 4
    s_cbranch_scc1 KG_LOOP
    s_nop 7
    s_mov_b32 s48, 0
    buffer_load_dword v112, v2, s[52:55], s48 offen
    s_mov_b32 s48, 262144
    buffer_load_dword v113, v2, s[52:55], s48 offen
    s_mov_b32 s48, 524288
    buffer_load_dword v114, v2, s[52:55], s48 offen
    s_mov_b32 s48, 786432
    buffer_load_dword v115, v2, s[52:55], s48 offen
    s_mov_b32 s48, 1048576
    buffer_load_dword v116, v2, s[52:55], s48 offen
    s_mov_b32 s48, 1310720
    buffer_load_dword v117, v2, s[52:55], s48 offen
    s_mov_b32 s48, 1572864
    buffer_load_dword v118, v2, s[52:55], s48 offen
    s_mov_b32 s48, 1835008
    buffer_load_dword v119, v2, s[52:55], s48 offen
    s_mul_i32 s50, s91, 2688
    s_add_u32 s50, s50, s51
    v_lshrrev_b32 v4, 4, v1
    v_lshlrev_b32 v4, 6, v4
    v_and_b32 v5, 15, v1
    v_add_u32 v4, v4, v5
    v_lshl_add_u32 v4, v4, 2, s50
    v_cmp_le_u32 s[82:83], 32, v1
    v_mov_b32 v8, s50
    v_mul_f32 v9, s94, v42
    s_waitcnt lgkmcnt(0)
    v_mul_f32 v192, v192, v42
    v_mul_f32 v193, v193, v42
    v_mul_f32 v194, v194, v42
    v_mul_f32 v195, v195, v42
    v_mul_f32 v196, v196, v42
    v_mul_f32 v197, v197, v42
    v_mul_f32 v198, v198, v42
    v_mul_f32 v199, v199, v42
    v_mul_f32 v200, v200, v42
    v_mul_f32 v201, v201, v42
    v_mul_f32 v202, v202, v42
    v_mul_f32 v203, v203, v42
    v_mul_f32 v204, v204, v42
    v_mul_f32 v205, v205, v42
    v_mul_f32 v206, v206, v42
    v_mul_f32 v207, v207, v42
    ds_write_b32 v8, v9 offset:2560
    ds_write_b32 v4, v192 offset:0
    ds_write_b32 v4, v193 offset:64
    ds_write_b32 v4, v194 offset:128
    ds_write_b32 v4, v195 offset:192
    s_mov_b64 exec, s[82:83]
    ds_write_b32 v4, v196 offset:512
    ds_write_b32 v4, v197 offset:576
    ds_write_b32 v4, v198 offset:640
    ds_write_b32 v4, v199 offset:704
    ds_write_b32 v4, v200 offset:1024
    ds_write_b32 v4, v201 offset:1088
    ds_write_b32 v4, v202 offset:1152
    ds_write_b32 v4, v203 offset:1216
    ds_write_b32 v4, v204 offset:1536
    ds_write_b32 v4, v205 offset:1600
    ds_write_b32 v4, v206 offset:1664
    ds_write_b32 v4, v207 offset:1728
    s_mov_b64 exec, -1
    s_waitcnt lgkmcnt(0)
    s_barrier
    ds_read_b32 v8, v96
    ds_read_b32 v24, v96 offset:2688
    ds_read_b32 v9, v97
    ds_read_b32 v25, v97 offset:2688
    ds_read_b32 v10, v98
    ds_read_b32 v26, v98 offset:2688
    ds_read_b32 v11, v99
    ds_read_b32 v27, v99 offset:2688
    ds_read_b32 v12, v100
    ds_read_b32 v28, v100 offset:2688
    ds_read_b32 v13, v101
    ds_read_b32 v29, v101 offset:2688
    ds_read_b32 v14, v102
    ds_read_b32 v30, v102 offset:2688
    ds_read_b32 v15, v103
    ds_read_b32 v31, v103 offset:2688
    ds_read_b32 v16, v104
    ds_read_b32 v32, v104 offset:2688
    ds_read_b32 v17, v105
    ds_read_b32 v33, v105 offset:2688
    ds_read_b32 v18, v106
    ds_read_b32 v34, v106 offset:2688
    ds_read_b32 v19, v107
    ds_read_b32 v35, v107 offset:2688
    ds_read_b32 v20, v108
    ds_read_b32 v36, v108 offset:2688
    ds_read_b32 v21, v109
    ds_read_b32 v37, v109 offset:2688
    ds_read_b32 v22, v110
    ds_read_b32 v38, v110 offset:2688
    ds_read_b32 v23, v111
    ds_read_b32 v39, v111 offset:2688
    s_lshl_b32 s50, s91, 11
    s_add_u32 s50, s50, s92
    s_add_u32 s50, s50, 9472
    v_lshlrev_b32 v4, 4, v1
    v_add_u32 v4, s50, v4
    v_mov_b32 v40, 0
    v_mov_b32 v41, 0
    v_mov_b32 v42, 0
    v_mov_b32 v43, 0
    s_waitcnt lgkmcnt(0)
    v_pk_add_f32 v[8:9], v[8:9], v[24:25]
    v_cvt_pk_bf16_f32 v48, v8, v9
    v_pk_add_f32 v[10:11], v[10:11], v[26:27]
    v_cvt_pk_bf16_f32 v49, v10, v11
    v_pk_add_f32 v[12:13], v[12:13], v[28:29]
    v_cvt_pk_bf16_f32 v50, v12, v13
    v_pk_add_f32 v[14:15], v[14:15], v[30:31]
    v_cvt_pk_bf16_f32 v51, v14, v15
    v_pk_add_f32 v[16:17], v[16:17], v[32:33]
    v_cvt_pk_bf16_f32 v52, v16, v17
    v_pk_add_f32 v[18:19], v[18:19], v[34:35]
    v_cvt_pk_bf16_f32 v53, v18, v19
    v_pk_add_f32 v[20:21], v[20:21], v[36:37]
    v_cvt_pk_bf16_f32 v54, v20, v21
    v_pk_add_f32 v[22:23], v[22:23], v[38:39]
    v_cvt_pk_bf16_f32 v55, v22, v23
    ds_write_b128 v4, v[48:51]
    ds_write_b128 v4, v[52:55] offset:1024
    v_mov_b32 v5, s92
    ds_write_b128 v5, v[40:43] offset:13568
    s_waitcnt lgkmcnt(0)
    s_barrier
    ds_read_b128 v[8:11], v4
    ds_read_b128 v[12:15], v4 offset:16
    ds_read_b128 v[24:27], v4 offset:1024
    ds_read_b128 v[28:31], v4 offset:1040
    s_lshl_b32 s50, s91, 7
    v_add_u32 v5, s50, v1
    v_sub_u32 v5, 194, v5
    v_and_b32 v6, 7, v5
    v_lshlrev_b32 v5, 7, v5
    v_lshl_add_u32 v5, v6, 4, v5
    v_add_u32 v5, s92, v5
    v_lshl_add_u32 v6, v1, 4, s92
    v_cmp_gt_u32 s[82:83], 24, v1
    s_cmp_eq_u32 s91, 0
    s_cselect_b32 s82, s82, 0
    s_cselect_b32 s83, s83, 0
    s_waitcnt lgkmcnt(0)
    s_barrier
    s_mov_b64 exec, s[82:83]
    ds_write_b128 v6, v[40:43]
    s_mov_b64 exec, -1
    v_alignbit_b32 v48, v9, v8, 16
    v_alignbit_b32 v54, v10, v9, 16
    v_mov_b32 v60, v9
    v_alignbit_b32 v49, v10, v9, 16
    v_alignbit_b32 v55, v11, v10, 16
    v_mov_b32 v61, v10
    v_alignbit_b32 v50, v11, v10, 16
    v_alignbit_b32 v56, v12, v11, 16
    v_mov_b32 v62, v11
    v_alignbit_b32 v51, v12, v11, 16
    v_alignbit_b32 v57, v13, v12, 16
    v_mov_b32 v63, v12
    v_alignbit_b32 v52, v13, v12, 16
    v_alignbit_b32 v58, v14, v13, 16
    v_mov_b32 v64, v13
    v_alignbit_b32 v53, v14, v13, 16
    v_alignbit_b32 v59, v15, v14, 16
    v_mov_b32 v65, v14
    v_xor_b32 v7, 112, v5
    ds_write_b128 v7, v[8:11] offset:8192
    v_xor_b32 v7, 96, v5
    ds_write_b128 v7, v[48:51] offset:8192
    v_xor_b32 v7, 80, v5
    ds_write_b128 v7, v[60:63] offset:8192
    v_xor_b32 v7, 64, v5
    ds_write_b128 v7, v[54:57] offset:8192
    v_xor_b32 v7, 48, v5
    ds_write_b128 v7, v[10:13] offset:8192
    v_xor_b32 v7, 32, v5
    ds_write_b128 v7, v[50:53] offset:8192
    v_xor_b32 v7, 16, v5
    ds_write_b128 v7, v[62:65] offset:8192
    v_xor_b32 v7, 0, v5
    ds_write_b128 v7, v[56:59] offset:8192
    v_alignbit_b32 v48, v25, v24, 16
    v_alignbit_b32 v54, v26, v25, 16
    v_mov_b32 v60, v25
    v_alignbit_b32 v49, v26, v25, 16
    v_alignbit_b32 v55, v27, v26, 16
    v_mov_b32 v61, v26
    v_alignbit_b32 v50, v27, v26, 16
    v_alignbit_b32 v56, v28, v27, 16
    v_mov_b32 v62, v27
    v_alignbit_b32 v51, v28, v27, 16
    v_alignbit_b32 v57, v29, v28, 16
    v_mov_b32 v63, v28
    v_alignbit_b32 v52, v29, v28, 16
    v_alignbit_b32 v58, v30, v29, 16
    v_mov_b32 v64, v29
    v_alignbit_b32 v53, v30, v29, 16
    v_alignbit_b32 v59, v31, v30, 16
    v_mov_b32 v65, v30
    v_xor_b32 v7, 112, v5
    ds_write_b128 v7, v[24:27] offset:0
    v_xor_b32 v7, 96, v5
    ds_write_b128 v7, v[48:51] offset:0
    v_xor_b32 v7, 80, v5
    ds_write_b128 v7, v[60:63] offset:0
    v_xor_b32 v7, 64, v5
    ds_write_b128 v7, v[54:57] offset:0
    v_xor_b32 v7, 48, v5
    ds_write_b128 v7, v[26:29] offset:0
    v_xor_b32 v7, 32, v5
    ds_write_b128 v7, v[50:53] offset:0
    v_xor_b32 v7, 16, v5
    ds_write_b128 v7, v[62:65] offset:0
    v_xor_b32 v7, 0, v5
    ds_write_b128 v7, v[56:59] offset:0
    s_add_u32 s56, s44, 10485760
    s_addc_u32 s57, s45, 0
    s_and_b32 s57, s57, 0xffff
    s_mov_b32 s58, 8192
    s_mov_b32 s59, 0x00020000
    s_waitcnt vmcnt(8)
    v_lshlrev_b32 v8, 16, v124
    v_and_b32 v9, 0xffff0000, v124
    v_lshlrev_b32 v12, 16, v120
    v_and_b32 v13, 0xffff0000, v120
    v_pk_mul_f32 v[8:9], v[8:9], v[12:13]
    v_cvt_pk_bf16_f32 v8, v8, v9
    v_and_b32 v9, 0xffff0000, v8
    v_lshlrev_b32 v8, 16, v8
    v_pk_add_f32 v[10:11], v[8:9], 0 op_sel_hi:[1,0]
    v_lshlrev_b32 v8, 16, v125
    v_and_b32 v9, 0xffff0000, v125
    v_lshlrev_b32 v12, 16, v121
    v_and_b32 v13, 0xffff0000, v121
    v_pk_mul_f32 v[8:9], v[8:9], v[12:13]
    v_cvt_pk_bf16_f32 v8, v8, v9
    v_and_b32 v9, 0xffff0000, v8
    v_lshlrev_b32 v8, 16, v8
    v_pk_add_f32 v[10:11], v[10:11], v[8:9]
    v_lshlrev_b32 v8, 16, v126
    v_and_b32 v9, 0xffff0000, v126
    v_lshlrev_b32 v12, 16, v122
    v_and_b32 v13, 0xffff0000, v122
    v_pk_mul_f32 v[8:9], v[8:9], v[12:13]
    v_cvt_pk_bf16_f32 v8, v8, v9
    v_and_b32 v9, 0xffff0000, v8
    v_lshlrev_b32 v8, 16, v8
    v_pk_add_f32 v[10:11], v[10:11], v[8:9]
    v_lshlrev_b32 v8, 16, v127
    v_and_b32 v9, 0xffff0000, v127
    v_lshlrev_b32 v12, 16, v123
    v_and_b32 v13, 0xffff0000, v123
    v_pk_mul_f32 v[8:9], v[8:9], v[12:13]
    v_cvt_pk_bf16_f32 v8, v8, v9
    v_and_b32 v9, 0xffff0000, v8
    v_lshlrev_b32 v8, 16, v8
    v_pk_add_f32 v[10:11], v[10:11], v[8:9]
    v_add_f32 v14, v10, v11
    v_lshlrev_b32 v8, 16, v128
    v_and_b32 v9, 0xffff0000, v128
    v_lshlrev_b32 v12, 16, v120
    v_and_b32 v13, 0xffff0000, v120
    v_pk_mul_f32 v[8:9], v[8:9], v[12:13]
    v_cvt_pk_bf16_f32 v8, v8, v9
    v_and_b32 v9, 0xffff0000, v8
    v_lshlrev_b32 v8, 16, v8
    v_pk_add_f32 v[10:11], v[8:9], 0 op_sel_hi:[1,0]
    v_lshlrev_b32 v8, 16, v129
    v_and_b32 v9, 0xffff0000, v129
    v_lshlrev_b32 v12, 16, v121
    v_and_b32 v13, 0xffff0000, v121
    v_pk_mul_f32 v[8:9], v[8:9], v[12:13]
    v_cvt_pk_bf16_f32 v8, v8, v9
    v_and_b32 v9, 0xffff0000, v8
    v_lshlrev_b32 v8, 16, v8
    v_pk_add_f32 v[10:11], v[10:11], v[8:9]
    v_lshlrev_b32 v8, 16, v130
    v_and_b32 v9, 0xffff0000, v130
    v_lshlrev_b32 v12, 16, v122
    v_and_b32 v13, 0xffff0000, v122
    v_pk_mul_f32 v[8:9], v[8:9], v[12:13]
    v_cvt_pk_bf16_f32 v8, v8, v9
    v_and_b32 v9, 0xffff0000, v8
    v_lshlrev_b32 v8, 16, v8
    v_pk_add_f32 v[10:11], v[10:11], v[8:9]
    v_lshlrev_b32 v8, 16, v131
    v_and_b32 v9, 0xffff0000, v131
    v_lshlrev_b32 v12, 16, v123
    v_and_b32 v13, 0xffff0000, v123
    v_pk_mul_f32 v[8:9], v[8:9], v[12:13]
    v_cvt_pk_bf16_f32 v8, v8, v9
    v_and_b32 v9, 0xffff0000, v8
    v_lshlrev_b32 v8, 16, v8
    v_pk_add_f32 v[10:11], v[10:11], v[8:9]
    v_add_f32 v15, v10, v11
    v_add_f32_dpp v14, v14, v14 row_shr:1 row_mask:0xf bank_mask:0xf bound_ctrl:0
    s_nop 0
    v_add_f32_dpp v15, v15, v15 row_shr:1 row_mask:0xf bank_mask:0xf bound_ctrl:0
    v_add_f32_dpp v14, v14, v14 row_shr:2 row_mask:0xf bank_mask:0xf bound_ctrl:0
    s_nop 0
    v_add_f32_dpp v15, v15, v15 row_shr:2 row_mask:0xf bank_mask:0xf bound_ctrl:0
    v_add_f32_dpp v14, v14, v14 row_shr:4 row_mask:0xf bank_mask:0xf bound_ctrl:0
    s_nop 0
    v_add_f32_dpp v15, v15, v15 row_shr:4 row_mask:0xf bank_mask:0xf bound_ctrl:0
    v_add_f32_dpp v14, v14, v14 row_shr:8 row_mask:0xf bank_mask:0xf bound_ctrl:0
    s_nop 0
    v_add_f32_dpp v15, v15, v15 row_shr:8 row_mask:0xf bank_mask:0xf bound_ctrl:0
    v_add_f32_dpp v14, v14, v14 row_bcast:15 row_mask:0xa bank_mask:0xf
    s_nop 0
    v_add_f32_dpp v15, v15, v15 row_bcast:15 row_mask:0xa bank_mask:0xf
    v_add_f32_dpp v14, v14, v14 row_bcast:31 row_mask:0xc bank_mask:0xf
    s_nop 0
    v_add_f32_dpp v15, v15, v15 row_bcast:31 row_mask:0xc bank_mask:0xf
    v_readlane_b32 s48, v14, 63
    v_readlane_b32 s50, v15, 63
    s_nop 0
    v_mov_b32 v8, s48
    v_writelane_b32 v8, s50, 1
    v_cvt_pk_bf16_f32 v8, v8, v8
    v_lshlrev_b32 v8, 16, v8
    v_mul_f32 v8, 0xbfb8aa3b, v8
    v_exp_f32 v8, v8
    s_nop 0
    v_add_f32 v8, 1.0, v8
    v_rcp_f32 v8, v8
    s_nop 0
    v_cvt_pk_bf16_f32 v8, v8, v8
    v_lshlrev_b32 v8, 16, v8
    s_lshl_b32 s48, s3, 2
    s_add_u32 s48, s48, s49
    s_lshl_b32 s48, s48, 3
    v_lshlrev_b32 v9, 2, v1
    s_mov_b64 exec, 3
    buffer_store_dword v8, v9, s[56:59], s48 offen
    s_mov_b64 exec, -1
    v_lshrrev_b32 v5, 5, v0
    v_mul_u32_u24 v5, 80, v5
    v_and_b32 v6, 31, v0
    v_lshlrev_b32 v6, 1, v6
    v_add_u32 v5, v5, v6
    v_add_u32 v5, 68864, v5
    s_waitcnt vmcnt(1)
    ds_write_b16 v5, v112 offset:0
    ds_write_b16_d16_hi v5, v112 offset:7680
    ds_write_b16 v5, v113 offset:640
    ds_write_b16_d16_hi v5, v113 offset:8320
    ds_write_b16 v5, v114 offset:1280
    ds_write_b16_d16_hi v5, v114 offset:8960
    ds_write_b16 v5, v115 offset:1920
    ds_write_b16_d16_hi v5, v115 offset:9600
    ds_write_b16 v5, v116 offset:2560
    ds_write_b16_d16_hi v5, v116 offset:10240
    ds_write_b16 v5, v117 offset:3200
    ds_write_b16_d16_hi v5, v117 offset:10880
    ds_write_b16 v5, v118 offset:3840
    ds_write_b16_d16_hi v5, v118 offset:11520
    ds_write_b16 v5, v119 offset:4480
    ds_write_b16_d16_hi v5, v119 offset:12160
    v_and_b32 v8, 31, v1
    v_lshrrev_b32 v9, 5, v1
    v_lshrrev_b32 v10, 3, v8
    v_sub_u32 v10, v10, v9
    s_lshl_b32 s50, s91, 1
    s_sub_u32 s50, 3, s50
    v_add_u32 v10, s50, v10
    v_and_b32 v11, 7, v8
    v_xor_b32 v11, v11, v10
    v_and_b32 v11, 7, v11
    v_lshlrev_b32 v10, 7, v10
    v_lshl_add_u32 v10, v11, 4, v10
    v_add_u32 v4, s92, v10
    v_xor_b32 v5, 64, v4
    v_mul_u32_u24 v10, 80, v8
    v_lshl_add_u32 v10, v9, 4, v10
    s_lshl_b32 s50, s91, 5
    s_add_u32 s50, s50, s93
    s_add_u32 s50, s50, 80
    v_add_u32 v6, s50, v10
    s_waitcnt lgkmcnt(0)
    s_barrier
    ds_read_b128 v[64:67], v4 offset:0
    ds_read_b128 v[72:75], v6 offset:2480
    ds_read_b128 v[76:79], v6 offset:5040
    ds_read_b128 v[68:71], v4 offset:16384
    ds_read_b128 v[80:83], v5 offset:512
    ds_read_b128 v[88:91], v6 offset:2400
    ds_read_b128 v[92:95], v6 offset:4960
    ds_read_b128 v[84:87], v5 offset:16896
    ds_read_b128 v[96:99], v4 offset:1024
    ds_read_b128 v[104:107], v6 offset:2320
    ds_read_b128 v[108:111], v6 offset:4880
    ds_read_b128 v[100:103], v4 offset:17408
    s_waitcnt lgkmcnt(8)
    v_mfma_f32_32x32x16_bf16 v[192:207], v[64:67], v[72:75], 0
    v_mfma_f32_32x32x16_bf16 v[208:223], v[64:67], v[76:79], 0
    v_mfma_f32_32x32x16_bf16 v[208:223], v[68:71], v[72:75], v[208:223]
    ds_read_b128 v[64:67], v5 offset:1536
    ds_read_b128 v[72:75], v6 offset:2240
    ds_read_b128 v[76:79], v6 offset:4800
    ds_read_b128 v[68:71], v5 offset:17920
    s_waitcnt lgkmcnt(8)
    v_mfma_f32_32x32x16_bf16 v[192:207], v[80:83], v[88:91], v[192:207]
    v_mfma_f32_32x32x16_bf16 v[208:223], v[80:83], v[92:95], v[208:223]
    v_mfma_f32_32x32x16_bf16 v[208:223], v[84:87], v[88:91], v[208:223]
    ds_read_b128 v[80:83], v4 offset:2048
    ds_read_b128 v[88:91], v6 offset:2160
    ds_read_b128 v[92:95], v6 offset:4720
    ds_read_b128 v[84:87], v4 offset:18432
    s_waitcnt lgkmcnt(8)
    v_mfma_f32_32x32x16_bf16 v[192:207], v[96:99], v[104:107], v[192:207]
    v_mfma_f32_32x32x16_bf16 v[208:223], v[96:99], v[108:111], v[208:223]
    v_mfma_f32_32x32x16_bf16 v[208:223], v[100:103], v[104:107], v[208:223]
    ds_read_b128 v[96:99], v5 offset:2560
    ds_read_b128 v[104:107], v6 offset:2080
    ds_read_b128 v[108:111], v6 offset:4640
    ds_read_b128 v[100:103], v5 offset:18944
    s_waitcnt lgkmcnt(8)
    v_mfma_f32_32x32x16_bf16 v[192:207], v[64:67], v[72:75], v[192:207]
    v_mfma_f32_32x32x16_bf16 v[208:223], v[64:67], v[76:79], v[208:223]
    v_mfma_f32_32x32x16_bf16 v[208:223], v[68:71], v[72:75], v[208:223]
    ds_read_b128 v[64:67], v4 offset:3072
    ds_read_b128 v[72:75], v6 offset:2000
    ds_read_b128 v[76:79], v6 offset:4560
    ds_read_b128 v[68:71], v4 offset:19456
    s_waitcnt lgkmcnt(8)
    v_mfma_f32_32x32x16_bf16 v[192:207], v[80:83], v[88:91], v[192:207]
    v_mfma_f32_32x32x16_bf16 v[208:223], v[80:83], v[92:95], v[208:223]
    v_mfma_f32_32x32x16_bf16 v[208:223], v[84:87], v[88:91], v[208:223]
    ds_read_b128 v[80:83], v5 offset:3584
    ds_read_b128 v[88:91], v6 offset:1920
    ds_read_b128 v[92:95], v6 offset:4480
    ds_read_b128 v[84:87], v5 offset:19968
    s_waitcnt lgkmcnt(8)
    v_mfma_f32_32x32x16_bf16 v[192:207], v[96:99], v[104:107], v[192:207]
    v_mfma_f32_32x32x16_bf16 v[208:223], v[96:99], v[108:111], v[208:223]
    v_mfma_f32_32x32x16_bf16 v[208:223], v[100:103], v[104:107], v[208:223]
    ds_read_b128 v[96:99], v4 offset:4096
    ds_read_b128 v[104:107], v6 offset:1840
    ds_read_b128 v[108:111], v6 offset:4400
    ds_read_b128 v[100:103], v4 offset:20480
    s_waitcnt lgkmcnt(8)
    v_mfma_f32_32x32x16_bf16 v[192:207], v[64:67], v[72:75], v[192:207]
    v_mfma_f32_32x32x16_bf16 v[208:223], v[64:67], v[76:79], v[208:223]
    v_mfma_f32_32x32x16_bf16 v[208:223], v[68:71], v[72:75], v[208:223]
    ds_read_b128 v[64:67], v5 offset:4608
    ds_read_b128 v[72:75], v6 offset:1760
    ds_read_b128 v[76:79], v6 offset:4320
    ds_read_b128 v[68:71], v5 offset:20992
    s_waitcnt lgkmcnt(8)
    v_mfma_f32_32x32x16_bf16 v[192:207], v[80:83], v[88:91], v[192:207]
    v_mfma_f32_32x32x16_bf16 v[208:223], v[80:83], v[92:95], v[208:223]
    v_mfma_f32_32x32x16_bf16 v[208:223], v[84:87], v[88:91], v[208:223]
    ds_read_b128 v[80:83], v4 offset:5120
    ds_read_b128 v[88:91], v6 offset:1680
    ds_read_b128 v[92:95], v6 offset:4240
    ds_read_b128 v[84:87], v4 offset:21504
    s_waitcnt lgkmcnt(8)
    v_mfma_f32_32x32x16_bf16 v[192:207], v[96:99], v[104:107], v[192:207]
    v_mfma_f32_32x32x16_bf16 v[208:223], v[96:99], v[108:111], v[208:223]
    v_mfma_f32_32x32x16_bf16 v[208:223], v[100:103], v[104:107], v[208:223]
    ds_read_b128 v[96:99], v5 offset:5632
    ds_read_b128 v[104:107], v6 offset:1600
    ds_read_b128 v[108:111], v6 offset:4160
    ds_read_b128 v[100:103], v5 offset:22016
    s_waitcnt lgkmcnt(8)
    v_mfma_f32_32x32x16_bf16 v[192:207], v[64:67], v[72:75], v[192:207]
    v_mfma_f32_32x32x16_bf16 v[208:223], v[64:67], v[76:79], v[208:223]
    v_mfma_f32_32x32x16_bf16 v[208:223], v[68:71], v[72:75], v[208:223]
    ds_read_b128 v[64:67], v4 offset:6144
    ds_read_b128 v[72:75], v6 offset:1520
    ds_read_b128 v[76:79], v6 offset:4080
    ds_read_b128 v[68:71], v4 offset:22528
    s_waitcnt lgkmcnt(8)
    v_mfma_f32_32x32x16_bf16 v[192:207], v[80:83], v[88:91], v[192:207]
    v_mfma_f32_32x32x16_bf16 v[208:223], v[80:83], v[92:95], v[208:223]
    v_mfma_f32_32x32x16_bf16 v[208:223], v[84:87], v[88:91], v[208:223]
    ds_read_b128 v[80:83], v5 offset:6656
    ds_read_b128 v[88:91], v6 offset:1440
    ds_read_b128 v[92:95], v6 offset:4000
    ds_read_b128 v[84:87], v5 offset:23040
    s_waitcnt lgkmcnt(8)
    v_mfma_f32_32x32x16_bf16 v[192:207], v[96:99], v[104:107], v[192:207]
    v_mfma_f32_32x32x16_bf16 v[208:223], v[96:99], v[108:111], v[208:223]
    v_mfma_f32_32x32x16_bf16 v[208:223], v[100:103], v[104:107], v[208:223]
    ds_read_b128 v[96:99], v4 offset:7168
    ds_read_b128 v[104:107], v6 offset:1360
    ds_read_b128 v[108:111], v6 offset:3920
    ds_read_b128 v[100:103], v4 offset:23552
    s_waitcnt lgkmcnt(8)
    v_mfma_f32_32x32x16_bf16 v[192:207], v[64:67], v[72:75], v[192:207]
    v_mfma_f32_32x32x16_bf16 v[208:223], v[64:67], v[76:79], v[208:223]
    v_mfma_f32_32x32x16_bf16 v[208:223], v[68:71], v[72:75], v[208:223]
    ds_read_b128 v[64:67], v5 offset:7680
    ds_read_b128 v[72:75], v6 offset:1280
    ds_read_b128 v[76:79], v6 offset:3840
    ds_read_b128 v[68:71], v5 offset:24064
    s_waitcnt lgkmcnt(8)
    v_mfma_f32_32x32x16_bf16 v[192:207], v[80:83], v[88:91], v[192:207]
    v_mfma_f32_32x32x16_bf16 v[208:223], v[80:83], v[92:95], v[208:223]
    v_mfma_f32_32x32x16_bf16 v[208:223], v[84:87], v[88:91], v[208:223]
    ds_read_b128 v[80:83], v4 offset:8192
    ds_read_b128 v[88:91], v6 offset:1200
    ds_read_b128 v[92:95], v6 offset:3760
    ds_read_b128 v[84:87], v4 offset:24576
    s_waitcnt lgkmcnt(8)
    v_mfma_f32_32x32x16_bf16 v[192:207], v[96:99], v[104:107], v[192:207]
    v_mfma_f32_32x32x16_bf16 v[208:223], v[96:99], v[108:111], v[208:223]
    v_mfma_f32_32x32x16_bf16 v[208:223], v[100:103], v[104:107], v[208:223]
    ds_read_b128 v[96:99], v5 offset:8704
    ds_read_b128 v[104:107], v6 offset:1120
    ds_read_b128 v[108:111], v6 offset:3680
    ds_read_b128 v[100:103], v5 offset:25088
    s_waitcnt lgkmcnt(8)
    v_mfma_f32_32x32x16_bf16 v[192:207], v[64:67], v[72:75], v[192:207]
    v_mfma_f32_32x32x16_bf16 v[208:223], v[64:67], v[76:79], v[208:223]
    v_mfma_f32_32x32x16_bf16 v[208:223], v[68:71], v[72:75], v[208:223]
    ds_read_b128 v[64:67], v4 offset:9216
    ds_read_b128 v[72:75], v6 offset:1040
    ds_read_b128 v[76:79], v6 offset:3600
    ds_read_b128 v[68:71], v4 offset:25600
    s_waitcnt lgkmcnt(8)
    v_mfma_f32_32x32x16_bf16 v[192:207], v[80:83], v[88:91], v[192:207]
    v_mfma_f32_32x32x16_bf16 v[208:223], v[80:83], v[92:95], v[208:223]
    v_mfma_f32_32x32x16_bf16 v[208:223], v[84:87], v[88:91], v[208:223]
    ds_read_b128 v[80:83], v5 offset:9728
    ds_read_b128 v[88:91], v6 offset:960
    ds_read_b128 v[92:95], v6 offset:3520
    ds_read_b128 v[84:87], v5 offset:26112
    s_waitcnt lgkmcnt(8)
    v_mfma_f32_32x32x16_bf16 v[192:207], v[96:99], v[104:107], v[192:207]
    v_mfma_f32_32x32x16_bf16 v[208:223], v[96:99], v[108:111], v[208:223]
    v_mfma_f32_32x32x16_bf16 v[208:223], v[100:103], v[104:107], v[208:223]
    ds_read_b128 v[96:99], v4 offset:10240
    ds_read_b128 v[104:107], v6 offset:880
    ds_read_b128 v[108:111], v6 offset:3440
    ds_read_b128 v[100:103], v4 offset:26624
    s_waitcnt lgkmcnt(8)
    v_mfma_f32_32x32x16_bf16 v[192:207], v[64:67], v[72:75], v[192:207]
    v_mfma_f32_32x32x16_bf16 v[208:223], v[64:67], v[76:79], v[208:223]
    v_mfma_f32_32x32x16_bf16 v[208:223], v[68:71], v[72:75], v[208:223]
    ds_read_b128 v[64:67], v5 offset:10752
    ds_read_b128 v[72:75], v6 offset:800
    ds_read_b128 v[76:79], v6 offset:3360
    ds_read_b128 v[68:71], v5 offset:27136
    s_waitcnt lgkmcnt(8)
    v_mfma_f32_32x32x16_bf16 v[192:207], v[80:83], v[88:91], v[192:207]
    v_mfma_f32_32x32x16_bf16 v[208:223], v[80:83], v[92:95], v[208:223]
    v_mfma_f32_32x32x16_bf16 v[208:223], v[84:87], v[88:91], v[208:223]
    ds_read_b128 v[80:83], v4 offset:11264
    ds_read_b128 v[88:91], v6 offset:720
    ds_read_b128 v[92:95], v6 offset:3280
    ds_read_b128 v[84:87], v4 offset:27648
    s_waitcnt lgkmcnt(8)
    v_mfma_f32_32x32x16_bf16 v[192:207], v[96:99], v[104:107], v[192:207]
    v_mfma_f32_32x32x16_bf16 v[208:223], v[96:99], v[108:111], v[208:223]
    v_mfma_f32_32x32x16_bf16 v[208:223], v[100:103], v[104:107], v[208:223]
    ds_read_b128 v[96:99], v5 offset:11776
    ds_read_b128 v[104:107], v6 offset:640
    ds_read_b128 v[108:111], v6 offset:3200
    ds_read_b128 v[100:103], v5 offset:28160
    s_waitcnt lgkmcnt(8)
    v_mfma_f32_32x32x16_bf16 v[192:207], v[64:67], v[72:75], v[192:207]
    v_mfma_f32_32x32x16_bf16 v[208:223], v[64:67], v[76:79], v[208:223]
    v_mfma_f32_32x32x16_bf16 v[208:223], v[68:71], v[72:75], v[208:223]
    ds_read_b128 v[64:67], v4 offset:12288
    ds_read_b128 v[72:75], v6 offset:560
    ds_read_b128 v[76:79], v6 offset:3120
    ds_read_b128 v[68:71], v4 offset:28672
    s_waitcnt lgkmcnt(8)
    v_mfma_f32_32x32x16_bf16 v[192:207], v[80:83], v[88:91], v[192:207]
    v_mfma_f32_32x32x16_bf16 v[208:223], v[80:83], v[92:95], v[208:223]
    v_mfma_f32_32x32x16_bf16 v[208:223], v[84:87], v[88:91], v[208:223]
    ds_read_b128 v[80:83], v5 offset:12800
    ds_read_b128 v[88:91], v6 offset:480
    ds_read_b128 v[92:95], v6 offset:3040
    ds_read_b128 v[84:87], v5 offset:29184
    s_waitcnt lgkmcnt(8)
    v_mfma_f32_32x32x16_bf16 v[192:207], v[96:99], v[104:107], v[192:207]
    v_mfma_f32_32x32x16_bf16 v[208:223], v[96:99], v[108:111], v[208:223]
    v_mfma_f32_32x32x16_bf16 v[208:223], v[100:103], v[104:107], v[208:223]
    ds_read_b128 v[96:99], v4 offset:13312
    ds_read_b128 v[104:107], v6 offset:400
    ds_read_b128 v[108:111], v6 offset:2960
    ds_read_b128 v[100:103], v4 offset:29696
    s_waitcnt lgkmcnt(8)
    v_mfma_f32_32x32x16_bf16 v[192:207], v[64:67], v[72:75], v[192:207]
    v_mfma_f32_32x32x16_bf16 v[208:223], v[64:67], v[76:79], v[208:223]
    v_mfma_f32_32x32x16_bf16 v[208:223], v[68:71], v[72:75], v[208:223]
    ds_read_b128 v[64:67], v5 offset:13824
    ds_read_b128 v[72:75], v6 offset:320
    ds_read_b128 v[76:79], v6 offset:2880
    ds_read_b128 v[68:71], v5 offset:30208
    s_waitcnt lgkmcnt(8)
    v_mfma_f32_32x32x16_bf16 v[192:207], v[80:83], v[88:91], v[192:207]
    v_mfma_f32_32x32x16_bf16 v[208:223], v[80:83], v[92:95], v[208:223]
    v_mfma_f32_32x32x16_bf16 v[208:223], v[84:87], v[88:91], v[208:223]
    ds_read_b128 v[80:83], v4 offset:14336
    ds_read_b128 v[88:91], v6 offset:240
    ds_read_b128 v[92:95], v6 offset:2800
    ds_read_b128 v[84:87], v4 offset:30720
    s_waitcnt lgkmcnt(8)
    v_mfma_f32_32x32x16_bf16 v[192:207], v[96:99], v[104:107], v[192:207]
    v_mfma_f32_32x32x16_bf16 v[208:223], v[96:99], v[108:111], v[208:223]
    v_mfma_f32_32x32x16_bf16 v[208:223], v[100:103], v[104:107], v[208:223]
    ds_read_b128 v[96:99], v5 offset:14848
    ds_read_b128 v[104:107], v6 offset:160
    ds_read_b128 v[108:111], v6 offset:2720
    ds_read_b128 v[100:103], v5 offset:31232
    s_waitcnt lgkmcnt(8)
    v_mfma_f32_32x32x16_bf16 v[192:207], v[64:67], v[72:75], v[192:207]
    v_mfma_f32_32x32x16_bf16 v[208:223], v[64:67], v[76:79], v[208:223]
    v_mfma_f32_32x32x16_bf16 v[208:223], v[68:71], v[72:75], v[208:223]
    ds_read_b128 v[64:67], v4 offset:15360
    ds_read_b128 v[72:75], v6 offset:80
    ds_read_b128 v[76:79], v6 offset:2640
    ds_read_b128 v[68:71], v4 offset:31744
    s_waitcnt lgkmcnt(8)
    v_mfma_f32_32x32x16_bf16 v[192:207], v[80:83], v[88:91], v[192:207]
    v_mfma_f32_32x32x16_bf16 v[208:223], v[80:83], v[92:95], v[208:223]
    v_mfma_f32_32x32x16_bf16 v[208:223], v[84:87], v[88:91], v[208:223]
    ds_read_b128 v[80:83], v5 offset:15872
    ds_read_b128 v[88:91], v6 offset:0
    ds_read_b128 v[92:95], v6 offset:2560
    ds_read_b128 v[84:87], v5 offset:32256
    s_waitcnt lgkmcnt(8)
    v_mfma_f32_32x32x16_bf16 v[192:207], v[96:99], v[104:107], v[192:207]
    v_mfma_f32_32x32x16_bf16 v[208:223], v[96:99], v[108:111], v[208:223]
    v_mfma_f32_32x32x16_bf16 v[208:223], v[100:103], v[104:107], v[208:223]
    s_waitcnt lgkmcnt(4)
    v_mfma_f32_32x32x16_bf16 v[192:207], v[64:67], v[72:75], v[192:207]
    v_mfma_f32_32x32x16_bf16 v[208:223], v[64:67], v[76:79], v[208:223]
    v_mfma_f32_32x32x16_bf16 v[208:223], v[68:71], v[72:75], v[208:223]
    s_waitcnt lgkmcnt(0)
    v_mfma_f32_32x32x16_bf16 v[192:207], v[80:83], v[88:91], v[192:207]
    v_mfma_f32_32x32x16_bf16 v[208:223], v[80:83], v[92:95], v[208:223]
    v_mfma_f32_32x32x16_bf16 v[208:223], v[84:87], v[88:91], v[208:223]
    s_nop 15
    s_nop 3
    s_cmp_eq_u32 s91, 0
    s_cbranch_scc1 CV_NOSWAP
    v_swap_b32 v192, v208
    v_swap_b32 v193, v209
    v_swap_b32 v194, v210
    v_swap_b32 v195, v211
    v_swap_b32 v196, v212
    v_swap_b32 v197, v213
    v_swap_b32 v198, v214
    v_swap_b32 v199, v215
    v_swap_b32 v200, v216
    v_swap_b32 v201, v217
    v_swap_b32 v202, v218
    v_swap_b32 v203, v219
    v_swap_b32 v204, v220
    v_swap_b32 v205, v221
    v_swap_b32 v206, v222
    v_swap_b32 v207, v223
CV_NOSWAP:
    s_lshl_b32 s50, s91, 12
    s_add_u32 s50, s50, s92
    v_lshl_add_u32 v4, v1, 4, s50
    v_xor_b32 v5, 4096, v4
    s_barrier
    ds_write_b128 v4, v[208:211] offset:0
    ds_write_b128 v4, v[212:215] offset:1024
    ds_write_b128 v4, v[216:219] offset:2048
    ds_write_b128 v4, v[220:223] offset:3072
    v_and_b32 v8, 31, v1
    v_lshrrev_b32 v9, 5, v1
    v_mul_u32_u24 v10, 80, v8
    v_lshl_add_u32 v10, v9, 3, v10
    s_mul_i32 s50, s91, 2560
    s_add_u32 s50, s50, s93
    s_add_u32 s50, s50, 2560
    v_add_u32 v6, s50, v10
    v_lshlrev_b32 v10, 6, v8
    v_lshl_add_u32 v10, v9, 3, v10
    s_lshl_b32 s50, s47, 12
    s_lshl_b32 s48, s91, 11
    s_add_u32 s50, s50, s48
    v_add_u32 v7, s50, v10
    v_mov_b32 v2, s81
    v_mov_b32 v3, s81
    ds_read_b64 v[64:65], v6 offset:0
    ds_read_b64 v[66:67], v6 offset:16
    ds_read_b64 v[68:69], v6 offset:32
    ds_read_b64 v[70:71], v6 offset:48
    s_waitcnt lgkmcnt(0)
    s_barrier
    ds_read_b128 v[80:83], v5 offset:0
    ds_read_b128 v[84:87], v5 offset:1024
    ds_read_b128 v[88:91], v5 offset:2048
    ds_read_b128 v[92:95], v5 offset:3072
    s_waitcnt lgkmcnt(0)
    v_pk_add_f32 v[192:193], v[192:193], v[80:81]
    v_lshlrev_b32 v8, 16, v64
    v_and_b32 v9, 0xffff0000, v64
    v_pk_mul_f32 v[8:9], v[8:9], v[2:3]
    v_cvt_pk_bf16_f32 v8, v8, v9
    v_cvt_pk_bf16_f32 v10, v192, v193
    v_and_b32 v9, 0xffff0000, v8
    v_lshlrev_b32 v8, 16, v8
    v_and_b32 v11, 0xffff0000, v10
    v_lshlrev_b32 v10, 16, v10
    v_pk_add_f32 v[8:9], v[8:9], v[10:11]
    v_cvt_pk_bf16_f32 v64, v8, v9
    v_pk_add_f32 v[194:195], v[194:195], v[82:83]
    v_lshlrev_b32 v8, 16, v65
    v_and_b32 v9, 0xffff0000, v65
    v_pk_mul_f32 v[8:9], v[8:9], v[2:3]
    v_cvt_pk_bf16_f32 v8, v8, v9
    v_cvt_pk_bf16_f32 v10, v194, v195
    v_and_b32 v9, 0xffff0000, v8
    v_lshlrev_b32 v8, 16, v8
    v_and_b32 v11, 0xffff0000, v10
    v_lshlrev_b32 v10, 16, v10
    v_pk_add_f32 v[8:9], v[8:9], v[10:11]
    v_cvt_pk_bf16_f32 v65, v8, v9
    buffer_store_dwordx2 v[64:65], v7, s[72:75], 0 offen offset:0
    v_pk_add_f32 v[196:197], v[196:197], v[84:85]
    v_lshlrev_b32 v8, 16, v66
    v_and_b32 v9, 0xffff0000, v66
    v_pk_mul_f32 v[8:9], v[8:9], v[2:3]
    v_cvt_pk_bf16_f32 v8, v8, v9
    v_cvt_pk_bf16_f32 v10, v196, v197
    v_and_b32 v9, 0xffff0000, v8
    v_lshlrev_b32 v8, 16, v8
    v_and_b32 v11, 0xffff0000, v10
    v_lshlrev_b32 v10, 16, v10
    v_pk_add_f32 v[8:9], v[8:9], v[10:11]
    v_cvt_pk_bf16_f32 v66, v8, v9
    v_pk_add_f32 v[198:199], v[198:199], v[86:87]
    v_lshlrev_b32 v8, 16, v67
    v_and_b32 v9, 0xffff0000, v67
    v_pk_mul_f32 v[8:9], v[8:9], v[2:3]
    v_cvt_pk_bf16_f32 v8, v8, v9
    v_cvt_pk_bf16_f32 v10, v198, v199
    v_and_b32 v9, 0xffff0000, v8
    v_lshlrev_b32 v8, 16, v8
    v_and_b32 v11, 0xffff0000, v10
    v_lshlrev_b32 v10, 16, v10
    v_pk_add_f32 v[8:9], v[8:9], v[10:11]
    v_cvt_pk_bf16_f32 v67, v8, v9
    buffer_store_dwordx2 v[66:67], v7, s[72:75], 0 offen offset:16
    v_pk_add_f32 v[200:201], v[200:201], v[88:89]
    v_lshlrev_b32 v8, 16, v68
    v_and_b32 v9, 0xffff0000, v68
    v_pk_mul_f32 v[8:9], v[8:9], v[2:3]
    v_cvt_pk_bf16_f32 v8, v8, v9
    v_cvt_pk_bf16_f32 v10, v200, v201
    v_and_b32 v9, 0xffff0000, v8
    v_lshlrev_b32 v8, 16, v8
    v_and_b32 v11, 0xffff0000, v10
    v_lshlrev_b32 v10, 16, v10
    v_pk_add_f32 v[8:9], v[8:9], v[10:11]
    v_cvt_pk_bf16_f32 v68, v8, v9
    v_pk_add_f32 v[202:203], v[202:203], v[90:91]
    v_lshlrev_b32 v8, 16, v69
    v_and_b32 v9, 0xffff0000, v69
    v_pk_mul_f32 v[8:9], v[8:9], v[2:3]
    v_cvt_pk_bf16_f32 v8, v8, v9
    v_cvt_pk_bf16_f32 v10, v202, v203
    v_and_b32 v9, 0xffff0000, v8
    v_lshlrev_b32 v8, 16, v8
    v_and_b32 v11, 0xffff0000, v10
    v_lshlrev_b32 v10, 16, v10
    v_pk_add_f32 v[8:9], v[8:9], v[10:11]
    v_cvt_pk_bf16_f32 v69, v8, v9
    buffer_store_dwordx2 v[68:69], v7, s[72:75], 0 offen offset:32
    v_pk_add_f32 v[204:205], v[204:205], v[92:93]
    v_lshlrev_b32 v8, 16, v70
    v_and_b32 v9, 0xffff0000, v70
    v_pk_mul_f32 v[8:9], v[8:9], v[2:3]
    v_cvt_pk_bf16_f32 v8, v8, v9
    v_cvt_pk_bf16_f32 v10, v204, v205
    v_and_b32 v9, 0xffff0000, v8
    v_lshlrev_b32 v8, 16, v8
    v_and_b32 v11, 0xffff0000, v10
    v_lshlrev_b32 v10, 16, v10
    v_pk_add_f32 v[8:9], v[8:9], v[10:11]
    v_cvt_pk_bf16_f32 v70, v8, v9
    v_pk_add_f32 v[206:207], v[206:207], v[94:95]
    v_lshlrev_b32 v8, 16, v71
    v_and_b32 v9, 0xffff0000, v71
    v_pk_mul_f32 v[8:9], v[8:9], v[2:3]
    v_cvt_pk_bf16_f32 v8, v8, v9
    v_cvt_pk_bf16_f32 v10, v206, v207
    v_and_b32 v9, 0xffff0000, v8
    v_lshlrev_b32 v8, 16, v8
    v_and_b32 v11, 0xffff0000, v10
    v_lshlrev_b32 v10, 16, v10
    v_pk_add_f32 v[8:9], v[8:9], v[10:11]
    v_cvt_pk_bf16_f32 v71, v8, v9
    buffer_store_dwordx2 v[70:71], v7, s[72:75], 0 offen offset:48
    s_endpgm
G1:
    s_sub_u32 s46, s2, 256
    s_and_b32 s47, s46, 1
    s_lshl_b32 s47, s47, 3
    s_bfe_u32 s48, s46, 0x30003
    s_add_u32 s47, s47, s48
    s_bfe_u32 s48, s46, 0x20001
    s_lshl_b32 s48, s48, 2
    s_lshr_b32 s50, s46, 6
    s_add_u32 s48, s48, s50
    s_mov_b32 s52, s16
    s_mov_b32 s53, s17
    s_and_b32 s53, s53, 0xffff
    s_mov_b32 s54, 2097152
    s_mov_b32 s55, 0x00020000
    s_cmp_lt_u32 s49, 2
    s_cselect_b32 s56, s32, s34
    s_cselect_b32 s57, s33, s35
    s_and_b32 s57, s57, 0xffff
    s_mov_b32 s58, 1409024
    s_mov_b32 s59, 0x00020000
    s_mov_b32 s64, s44
    s_mov_b32 s65, s45
    s_and_b32 s65, s65, 0xffff
    s_mov_b32 s66, 5636096
    s_mov_b32 s67, 0x00020000
    s_lshl_b32 s50, s47, 7
    s_lshl_b32 s51, s49, 5
    s_add_u32 s50, s50, s51
    v_lshrrev_b32 v3, 2, v1
    v_add_u32 v2, s50, v3
    v_lshlrev_b32 v2, 10, v2
    v_and_b32 v4, 3, v1
    v_lshl_add_u32 v2, v4, 4, v2
    s_movk_i32 s76, 0x4000
    s_lshl_b32 s50, s49, 11
    s_add_u32 s50, s50, 73728
    v_lshrrev_b32 v5, 1, v4
    v_bfe_u32 v6, v3, 2, 1
    v_xor_b32 v5, v5, v6
    v_and_b32 v4, 1, v4
    v_lshlrev_b32 v4, 4, v4
    v_lshl_add_u32 v4, v5, 5, v4
    v_lshl_add_u32 v4, v3, 6, v4
    v_add_u32 v0, s50, v4
    v_and_b32 v3, 31, v1
    v_lshrrev_b32 v4, 5, v1
    v_bfe_u32 v5, v3, 2, 1
    v_xor_b32 v4, v4, v5
    v_lshlrev_b32 v4, 5, v4
    v_lshl_add_u32 v4, v3, 6, v4
    v_add_u32 v31, s50, v4
    buffer_load_dwordx4 v[32:35], v2, s[52:55], 0 offen offset:0
    buffer_load_dwordx4 v[36:39], v2, s[52:55], s76 offen offset:0
    buffer_load_dwordx4 v[40:43], v2, s[52:55], 0 offen offset:64
    buffer_load_dwordx4 v[44:47], v2, s[52:55], s76 offen offset:64
    s_and_b32 s50, s49, 1
    s_mul_i32 s50, s50, 192
    s_mul_i32 s51, s48, 192
    v_add_u32 v6, s50, v1
    v_add_u32 v6, 0, v6
    v_mul_u32_u24 v7, 43691, v6
    v_lshrrev_b32 v7, 19, v7
    v_mul_u32_u24 v8, 12, v7
    v_sub_u32 v8, v6, v8
    v_mul_u32_u24 v7, 2752, v7
    v_lshlrev_b32 v8, 4, v8
    v_add3_u32 v3, v7, v8, s51
    v_add_u32 v6, s50, v1
    v_add_u32 v6, 64, v6
    v_mul_u32_u24 v7, 43691, v6
    v_lshrrev_b32 v7, 19, v7
    v_mul_u32_u24 v8, 12, v7
    v_sub_u32 v8, v6, v8
    v_mul_u32_u24 v7, 2752, v7
    v_lshlrev_b32 v8, 4, v8
    v_add3_u32 v4, v7, v8, s51
    v_add_u32 v6, s50, v1
    v_add_u32 v6, 128, v6
    v_mul_u32_u24 v7, 43691, v6
    v_lshrrev_b32 v7, 19, v7
    v_mul_u32_u24 v8, 12, v7
    v_sub_u32 v8, v6, v8
    v_mul_u32_u24 v7, 2752, v7
    v_lshlrev_b32 v8, 4, v8
    v_add3_u32 v5, v7, v8, s51
    s_mul_i32 s51, s49, 3072
    s_mov_b32 s50, 0
    s_add_u32 m0, s51, 0
    s_nop 0
    buffer_load_dwordx4 v3, s[56:59], s50 offen lds
    s_add_u32 m0, s51, 1024
    s_nop 0
    buffer_load_dwordx4 v4, s[56:59], s50 offen lds
    s_add_u32 m0, s51, 2048
    s_nop 0
    buffer_load_dwordx4 v5, s[56:59], s50 offen lds
    s_mov_b32 s50, 88064
    s_add_u32 m0, s51, 12288
    s_nop 0
    buffer_load_dwordx4 v3, s[56:59], s50 offen lds
    s_add_u32 m0, s51, 13312
    s_nop 0
    buffer_load_dwordx4 v4, s[56:59], s50 offen lds
    s_add_u32 m0, s51, 14336
    s_nop 0
    buffer_load_dwordx4 v5, s[56:59], s50 offen lds
    buffer_load_dwordx4 v[48:51], v2, s[52:55], 0 offen offset:128
    buffer_load_dwordx4 v[52:55], v2, s[52:55], s76 offen offset:128
    buffer_load_dwordx4 v[56:59], v2, s[52:55], 0 offen offset:192
    buffer_load_dwordx4 v[60:63], v2, s[52:55], s76 offen offset:192
    s_mov_b32 s50, 176128
    s_add_u32 m0, s51, 24576
    s_nop 0
    buffer_load_dwordx4 v3, s[56:59], s50 offen lds
    s_add_u32 m0, s51, 25600
    s_nop 0
    buffer_load_dwordx4 v4, s[56:59], s50 offen lds
    s_add_u32 m0, s51, 26624
    s_nop 0
    buffer_load_dwordx4 v5, s[56:59], s50 offen lds
    s_mov_b32 s50, 264192
    s_add_u32 m0, s51, 36864
    s_nop 0
    buffer_load_dwordx4 v3, s[56:59], s50 offen lds
    s_add_u32 m0, s51, 37888
    s_nop 0
    buffer_load_dwordx4 v4, s[56:59], s50 offen lds
    s_add_u32 m0, s51, 38912
    s_nop 0
    buffer_load_dwordx4 v5, s[56:59], s50 offen lds
    buffer_load_dwordx4 v[64:67], v2, s[52:55], 0 offen offset:256
    buffer_load_dwordx4 v[68:71], v2, s[52:55], s76 offen offset:256
    buffer_load_dwordx4 v[72:75], v2, s[52:55], 0 offen offset:320
    buffer_load_dwordx4 v[76:79], v2, s[52:55], s76 offen offset:320
    s_mov_b32 s50, 352256
    s_add_u32 m0, s51, 49152
    s_nop 0
    buffer_load_dwordx4 v3, s[56:59], s50 offen lds
    s_add_u32 m0, s51, 50176
    s_nop 0
    buffer_load_dwordx4 v4, s[56:59], s50 offen lds
    s_add_u32 m0, s51, 51200
    s_nop 0
    buffer_load_dwordx4 v5, s[56:59], s50 offen lds
    buffer_load_dwordx4 v[80:83], v2, s[52:55], 0 offen offset:384
    buffer_load_dwordx4 v[84:87], v2, s[52:55], s76 offen offset:384
    buffer_load_dwordx4 v[88:91], v2, s[52:55], 0 offen offset:448
    buffer_load_dwordx4 v[92:95], v2, s[52:55], s76 offen offset:448
    v_and_b32 v8, 15, v1
    v_lshrrev_b32 v9, 5, v1
    v_lshlrev_b32 v9, 4, v9
    v_lshrrev_b32 v10, 2, v8
    v_add_u32 v9, v9, v10
    v_mul_u32_u24 v9, 192, v9
    v_lshrrev_b32 v10, 4, v1
    v_and_b32 v10, 1, v10
    v_lshlrev_b32 v10, 5, v10
    v_and_b32 v11, 3, v8
    v_lshlrev_b32 v11, 3, v11
    v_add3_u32 v6, v9, v10, v11
    v_add_u32 v7, 49152, v6
    v_mov_b32 v1, v31
    s_setprio 2
    s_waitcnt vmcnt(29)
    ds_write_b128 v0, v[32:35] offset:0
    ds_write_b128 v0, v[36:39] offset:1024
    ds_read_b128 v[32:35], v1 offset:0
    ds_read_b128 v[36:39], v1 offset:16
    s_waitcnt vmcnt(24)
    s_barrier
    ds_read_b64_tr_b16 v[8:9], v6 offset:0
    ds_read_b64_tr_b16 v[10:11], v6 offset:768
    ds_read_b64_tr_b16 v[12:13], v6 offset:64
    ds_read_b64_tr_b16 v[14:15], v6 offset:832
    ds_read_b64_tr_b16 v[16:17], v6 offset:128
    ds_read_b64_tr_b16 v[18:19], v6 offset:896
    ds_read_b64_tr_b16 v[20:21], v6 offset:6144
    ds_read_b64_tr_b16 v[22:23], v6 offset:6912
    ds_read_b64_tr_b16 v[24:25], v6 offset:6208
    ds_read_b64_tr_b16 v[26:27], v6 offset:6976
    s_waitcnt lgkmcnt(10)
    s_waitcnt lgkmcnt(8)
    v_mfma_f32_32x32x16_bf16 v[160:175], v[8:11], v[32:35], 0
    ds_read_b64_tr_b16 v[28:29], v6 offset:6272
    ds_read_b64_tr_b16 v[30:31], v6 offset:7040
    s_waitcnt lgkmcnt(8)
    v_mfma_f32_32x32x16_bf16 v[176:191], v[12:15], v[32:35], 0
    s_waitcnt vmcnt(21)
    s_barrier
    s_mov_b32 s50, 440320
    s_add_u32 m0, s51, 61440
    s_nop 0
    buffer_load_dwordx4 v3, s[56:59], s50 offen lds
    s_add_u32 m0, s51, 62464
    s_nop 0
    buffer_load_dwordx4 v4, s[56:59], s50 offen lds
    s_add_u32 m0, s51, 63488
    s_nop 0
    buffer_load_dwordx4 v5, s[56:59], s50 offen lds
    buffer_load_dwordx4 v[96:99], v2, s[52:55], 0 offen offset:512
    buffer_load_dwordx4 v[100:103], v2, s[52:55], s76 offen offset:512
    buffer_load_dwordx4 v[104:107], v2, s[52:55], 0 offen offset:576
    buffer_load_dwordx4 v[108:111], v2, s[52:55], s76 offen offset:576
    ds_read_b64_tr_b16 v[8:9], v6 offset:1536
    ds_read_b64_tr_b16 v[10:11], v6 offset:2304
    s_waitcnt lgkmcnt(8)
    v_mfma_f32_32x32x16_bf16 v[192:207], v[16:19], v[32:35], 0
    ds_read_b64_tr_b16 v[12:13], v6 offset:1600
    ds_read_b64_tr_b16 v[14:15], v6 offset:2368
    s_waitcnt lgkmcnt(8)
    v_mfma_f32_32x32x16_bf16 v[208:223], v[20:23], v[32:35], 0
    ds_read_b64_tr_b16 v[16:17], v6 offset:1664
    ds_read_b64_tr_b16 v[18:19], v6 offset:2432
    s_waitcnt lgkmcnt(8)
    v_mfma_f32_32x32x16_bf16 v[224:239], v[24:27], v[32:35], 0
    ds_read_b64_tr_b16 v[20:21], v6 offset:7680
    ds_read_b64_tr_b16 v[22:23], v6 offset:8448
    ds_write_b128 v0, v[40:43] offset:0
    ds_write_b128 v0, v[44:47] offset:1024
    ds_read_b128 v[40:43], v1 offset:0
    ds_read_b128 v[44:47], v1 offset:16
    s_waitcnt lgkmcnt(12)
    v_mfma_f32_32x32x16_bf16 v[240:255], v[28:31], v[32:35], 0
    ds_read_b64_tr_b16 v[24:25], v6 offset:7744
    ds_read_b64_tr_b16 v[26:27], v6 offset:8512
    s_waitcnt lgkmcnt(12)
    v_mfma_f32_32x32x16_bf16 v[160:175], v[8:11], v[36:39], v[160:175]
    ds_read_b64_tr_b16 v[28:29], v6 offset:7808
    ds_read_b64_tr_b16 v[30:31], v6 offset:8576
    s_waitcnt lgkmcnt(12)
    v_mfma_f32_32x32x16_bf16 v[176:191], v[12:15], v[36:39], v[176:191]
    ds_read_b64_tr_b16 v[8:9], v6 offset:12288
    ds_read_b64_tr_b16 v[10:11], v6 offset:13056
    s_waitcnt lgkmcnt(12)
    v_mfma_f32_32x32x16_bf16 v[192:207], v[16:19], v[36:39], v[192:207]
    ds_read_b64_tr_b16 v[12:13], v6 offset:12352
    ds_read_b64_tr_b16 v[14:15], v6 offset:13120
    s_waitcnt lgkmcnt(12)
    v_mfma_f32_32x32x16_bf16 v[208:223], v[20:23], v[36:39], v[208:223]
    ds_read_b64_tr_b16 v[16:17], v6 offset:12416
    ds_read_b64_tr_b16 v[18:19], v6 offset:13184
    s_waitcnt lgkmcnt(8)
    v_mfma_f32_32x32x16_bf16 v[224:239], v[24:27], v[36:39], v[224:239]
    ds_read_b64_tr_b16 v[20:21], v6 offset:18432
    ds_read_b64_tr_b16 v[22:23], v6 offset:19200
    s_waitcnt lgkmcnt(8)
    v_mfma_f32_32x32x16_bf16 v[240:255], v[28:31], v[36:39], v[240:255]
    ds_read_b64_tr_b16 v[24:25], v6 offset:18496
    ds_read_b64_tr_b16 v[26:27], v6 offset:19264
    s_waitcnt lgkmcnt(8)
    v_mfma_f32_32x32x16_bf16 v[160:175], v[8:11], v[40:43], v[160:175]
    ds_read_b64_tr_b16 v[28:29], v6 offset:18560
    ds_read_b64_tr_b16 v[30:31], v6 offset:19328
    s_waitcnt lgkmcnt(8)
    v_mfma_f32_32x32x16_bf16 v[176:191], v[12:15], v[40:43], v[176:191]
    s_waitcnt vmcnt(21)
    s_barrier
    s_mov_b32 s50, 528384
    s_add_u32 m0, s51, 0
    s_nop 0
    buffer_load_dwordx4 v3, s[56:59], s50 offen lds
    s_add_u32 m0, s51, 1024
    s_nop 0
    buffer_load_dwordx4 v4, s[56:59], s50 offen lds
    s_add_u32 m0, s51, 2048
    s_nop 0
    buffer_load_dwordx4 v5, s[56:59], s50 offen lds
    ds_read_b64_tr_b16 v[8:9], v6 offset:13824
    ds_read_b64_tr_b16 v[10:11], v6 offset:14592
    s_waitcnt lgkmcnt(8)
    v_mfma_f32_32x32x16_bf16 v[192:207], v[16:19], v[40:43], v[192:207]
    ds_read_b64_tr_b16 v[12:13], v6 offset:13888
    ds_read_b64_tr_b16 v[14:15], v6 offset:14656
    s_waitcnt lgkmcnt(8)
    v_mfma_f32_32x32x16_bf16 v[208:223], v[20:23], v[40:43], v[208:223]
    ds_read_b64_tr_b16 v[16:17], v6 offset:13952
    ds_read_b64_tr_b16 v[18:19], v6 offset:14720
    s_waitcnt lgkmcnt(8)
    v_mfma_f32_32x32x16_bf16 v[224:239], v[24:27], v[40:43], v[224:239]
    ds_read_b64_tr_b16 v[20:21], v6 offset:19968
    ds_read_b64_tr_b16 v[22:23], v6 offset:20736
    ds_write_b128 v0, v[48:51] offset:0
    ds_write_b128 v0, v[52:55] offset:1024
    ds_read_b128 v[48:51], v1 offset:0
    ds_read_b128 v[52:55], v1 offset:16
    s_waitcnt lgkmcnt(12)
    v_mfma_f32_32x32x16_bf16 v[240:255], v[28:31], v[40:43], v[240:255]
    ds_read_b64_tr_b16 v[24:25], v6 offset:20032
    ds_read_b64_tr_b16 v[26:27], v6 offset:20800
    s_waitcnt lgkmcnt(12)
    v_mfma_f32_32x32x16_bf16 v[160:175], v[8:11], v[44:47], v[160:175]
    ds_read_b64_tr_b16 v[28:29], v6 offset:20096
    ds_read_b64_tr_b16 v[30:31], v6 offset:20864
    s_waitcnt lgkmcnt(12)
    v_mfma_f32_32x32x16_bf16 v[176:191], v[12:15], v[44:47], v[176:191]
    ds_read_b64_tr_b16 v[8:9], v6 offset:24576
    ds_read_b64_tr_b16 v[10:11], v6 offset:25344
    s_waitcnt lgkmcnt(12)
    v_mfma_f32_32x32x16_bf16 v[192:207], v[16:19], v[44:47], v[192:207]
    ds_read_b64_tr_b16 v[12:13], v6 offset:24640
    ds_read_b64_tr_b16 v[14:15], v6 offset:25408
    s_waitcnt lgkmcnt(12)
    v_mfma_f32_32x32x16_bf16 v[208:223], v[20:23], v[44:47], v[208:223]
    ds_read_b64_tr_b16 v[16:17], v6 offset:24704
    ds_read_b64_tr_b16 v[18:19], v6 offset:25472
    s_waitcnt lgkmcnt(8)
    v_mfma_f32_32x32x16_bf16 v[224:239], v[24:27], v[44:47], v[224:239]
    ds_read_b64_tr_b16 v[20:21], v6 offset:30720
    ds_read_b64_tr_b16 v[22:23], v6 offset:31488
    s_waitcnt lgkmcnt(8)
    v_mfma_f32_32x32x16_bf16 v[240:255], v[28:31], v[44:47], v[240:255]
    ds_read_b64_tr_b16 v[24:25], v6 offset:30784
    ds_read_b64_tr_b16 v[26:27], v6 offset:31552
    s_waitcnt lgkmcnt(8)
    v_mfma_f32_32x32x16_bf16 v[160:175], v[8:11], v[48:51], v[160:175]
    ds_read_b64_tr_b16 v[28:29], v6 offset:30848
    ds_read_b64_tr_b16 v[30:31], v6 offset:31616
    s_waitcnt lgkmcnt(8)
    v_mfma_f32_32x32x16_bf16 v[176:191], v[12:15], v[48:51], v[176:191]
    s_waitcnt vmcnt(21)
    s_barrier
    s_mov_b32 s50, 616448
    s_add_u32 m0, s51, 12288
    s_nop 0
    buffer_load_dwordx4 v3, s[56:59], s50 offen lds
    s_add_u32 m0, s51, 13312
    s_nop 0
    buffer_load_dwordx4 v4, s[56:59], s50 offen lds
    s_add_u32 m0, s51, 14336
    s_nop 0
    buffer_load_dwordx4 v5, s[56:59], s50 offen lds
    buffer_load_dwordx4 v[112:115], v2, s[52:55], 0 offen offset:640
    buffer_load_dwordx4 v[116:119], v2, s[52:55], s76 offen offset:640
    buffer_load_dwordx4 v[120:123], v2, s[52:55], 0 offen offset:704
    buffer_load_dwordx4 v[124:127], v2, s[52:55], s76 offen offset:704
    ds_read_b64_tr_b16 v[8:9], v6 offset:26112
    ds_read_b64_tr_b16 v[10:11], v6 offset:26880
    s_waitcnt lgkmcnt(8)
    v_mfma_f32_32x32x16_bf16 v[192:207], v[16:19], v[48:51], v[192:207]
    ds_read_b64_tr_b16 v[12:13], v6 offset:26176
    ds_read_b64_tr_b16 v[14:15], v6 offset:26944
    s_waitcnt lgkmcnt(8)
    v_mfma_f32_32x32x16_bf16 v[208:223], v[20:23], v[48:51], v[208:223]
    ds_read_b64_tr_b16 v[16:17], v6 offset:26240
    ds_read_b64_tr_b16 v[18:19], v6 offset:27008
    s_waitcnt lgkmcnt(8)
    v_mfma_f32_32x32x16_bf16 v[224:239], v[24:27], v[48:51], v[224:239]
    ds_read_b64_tr_b16 v[20:21], v6 offset:32256
    ds_read_b64_tr_b16 v[22:23], v6 offset:33024
    ds_write_b128 v0, v[56:59] offset:0
    ds_write_b128 v0, v[60:63] offset:1024
    ds_read_b128 v[56:59], v1 offset:0
    ds_read_b128 v[60:63], v1 offset:16
    s_waitcnt lgkmcnt(12)
    v_mfma_f32_32x32x16_bf16 v[240:255], v[28:31], v[48:51], v[240:255]
    ds_read_b64_tr_b16 v[24:25], v6 offset:32320
    ds_read_b64_tr_b16 v[26:27], v6 offset:33088
    s_waitcnt lgkmcnt(12)
    v_mfma_f32_32x32x16_bf16 v[160:175], v[8:11], v[52:55], v[160:175]
    ds_read_b64_tr_b16 v[28:29], v6 offset:32384
    ds_read_b64_tr_b16 v[30:31], v6 offset:33152
    s_waitcnt lgkmcnt(12)
    v_mfma_f32_32x32x16_bf16 v[176:191], v[12:15], v[52:55], v[176:191]
    ds_read_b64_tr_b16 v[8:9], v6 offset:36864
    ds_read_b64_tr_b16 v[10:11], v6 offset:37632
    s_waitcnt lgkmcnt(12)
    v_mfma_f32_32x32x16_bf16 v[192:207], v[16:19], v[52:55], v[192:207]
    ds_read_b64_tr_b16 v[12:13], v6 offset:36928
    ds_read_b64_tr_b16 v[14:15], v6 offset:37696
    s_waitcnt lgkmcnt(12)
    v_mfma_f32_32x32x16_bf16 v[208:223], v[20:23], v[52:55], v[208:223]
    ds_read_b64_tr_b16 v[16:17], v6 offset:36992
    ds_read_b64_tr_b16 v[18:19], v6 offset:37760
    s_waitcnt lgkmcnt(8)
    v_mfma_f32_32x32x16_bf16 v[224:239], v[24:27], v[52:55], v[224:239]
    ds_read_b64_tr_b16 v[20:21], v6 offset:43008
    ds_read_b64_tr_b16 v[22:23], v6 offset:43776
    s_waitcnt lgkmcnt(8)
    v_mfma_f32_32x32x16_bf16 v[240:255], v[28:31], v[52:55], v[240:255]
    ds_read_b64_tr_b16 v[24:25], v6 offset:43072
    ds_read_b64_tr_b16 v[26:27], v6 offset:43840
    s_waitcnt lgkmcnt(8)
    v_mfma_f32_32x32x16_bf16 v[160:175], v[8:11], v[56:59], v[160:175]
    ds_read_b64_tr_b16 v[28:29], v6 offset:43136
    ds_read_b64_tr_b16 v[30:31], v6 offset:43904
    s_waitcnt lgkmcnt(8)
    v_mfma_f32_32x32x16_bf16 v[176:191], v[12:15], v[56:59], v[176:191]
    s_waitcnt vmcnt(21)
    s_barrier
    s_mov_b32 s50, 704512
    s_add_u32 m0, s51, 24576
    s_nop 0
    buffer_load_dwordx4 v3, s[56:59], s50 offen lds
    s_add_u32 m0, s51, 25600
    s_nop 0
    buffer_load_dwordx4 v4, s[56:59], s50 offen lds
    s_add_u32 m0, s51, 26624
    s_nop 0
    buffer_load_dwordx4 v5, s[56:59], s50 offen lds
    ds_read_b64_tr_b16 v[8:9], v6 offset:38400
    ds_read_b64_tr_b16 v[10:11], v6 offset:39168
    s_waitcnt lgkmcnt(8)
    v_mfma_f32_32x32x16_bf16 v[192:207], v[16:19], v[56:59], v[192:207]
    ds_read_b64_tr_b16 v[12:13], v6 offset:38464
    ds_read_b64_tr_b16 v[14:15], v6 offset:39232
    s_waitcnt lgkmcnt(8)
    v_mfma_f32_32x32x16_bf16 v[208:223], v[20:23], v[56:59], v[208:223]
    ds_read_b64_tr_b16 v[16:17], v6 offset:38528
    ds_read_b64_tr_b16 v[18:19], v6 offset:39296
    s_waitcnt lgkmcnt(8)
    v_mfma_f32_32x32x16_bf16 v[224:239], v[24:27], v[56:59], v[224:239]
    ds_read_b64_tr_b16 v[20:21], v6 offset:44544
    ds_read_b64_tr_b16 v[22:23], v6 offset:45312
    ds_write_b128 v0, v[64:67] offset:0
    ds_write_b128 v0, v[68:71] offset:1024
    ds_read_b128 v[64:67], v1 offset:0
    ds_read_b128 v[68:71], v1 offset:16
    s_waitcnt lgkmcnt(12)
    v_mfma_f32_32x32x16_bf16 v[240:255], v[28:31], v[56:59], v[240:255]
    ds_read_b64_tr_b16 v[24:25], v6 offset:44608
    ds_read_b64_tr_b16 v[26:27], v6 offset:45376
    s_waitcnt lgkmcnt(12)
    v_mfma_f32_32x32x16_bf16 v[160:175], v[8:11], v[60:63], v[160:175]
    ds_read_b64_tr_b16 v[28:29], v6 offset:44672
    ds_read_b64_tr_b16 v[30:31], v6 offset:45440
    s_waitcnt lgkmcnt(12)
    v_mfma_f32_32x32x16_bf16 v[176:191], v[12:15], v[60:63], v[176:191]
    ds_read_b64_tr_b16 v[8:9], v7 offset:0
    ds_read_b64_tr_b16 v[10:11], v7 offset:768
    s_waitcnt lgkmcnt(12)
    v_mfma_f32_32x32x16_bf16 v[192:207], v[16:19], v[60:63], v[192:207]
    ds_read_b64_tr_b16 v[12:13], v7 offset:64
    ds_read_b64_tr_b16 v[14:15], v7 offset:832
    s_waitcnt lgkmcnt(12)
    v_mfma_f32_32x32x16_bf16 v[208:223], v[20:23], v[60:63], v[208:223]
    ds_read_b64_tr_b16 v[16:17], v7 offset:128
    ds_read_b64_tr_b16 v[18:19], v7 offset:896
    s_waitcnt lgkmcnt(8)
    v_mfma_f32_32x32x16_bf16 v[224:239], v[24:27], v[60:63], v[224:239]
    ds_read_b64_tr_b16 v[20:21], v7 offset:6144
    ds_read_b64_tr_b16 v[22:23], v7 offset:6912
    s_waitcnt lgkmcnt(8)
    v_mfma_f32_32x32x16_bf16 v[240:255], v[28:31], v[60:63], v[240:255]
    ds_read_b64_tr_b16 v[24:25], v7 offset:6208
    ds_read_b64_tr_b16 v[26:27], v7 offset:6976
    s_waitcnt lgkmcnt(8)
    v_mfma_f32_32x32x16_bf16 v[160:175], v[8:11], v[64:67], v[160:175]
    ds_read_b64_tr_b16 v[28:29], v7 offset:6272
    ds_read_b64_tr_b16 v[30:31], v7 offset:7040
    s_waitcnt lgkmcnt(8)
    v_mfma_f32_32x32x16_bf16 v[176:191], v[12:15], v[64:67], v[176:191]
    s_waitcnt vmcnt(17)
    s_barrier
    s_mov_b32 s50, 792576
    s_add_u32 m0, s51, 36864
    s_nop 0
    buffer_load_dwordx4 v3, s[56:59], s50 offen lds
    s_add_u32 m0, s51, 37888
    s_nop 0
    buffer_load_dwordx4 v4, s[56:59], s50 offen lds
    s_add_u32 m0, s51, 38912
    s_nop 0
    buffer_load_dwordx4 v5, s[56:59], s50 offen lds
    buffer_load_dwordx4 v[128:131], v2, s[52:55], 0 offen offset:768
    buffer_load_dwordx4 v[132:135], v2, s[52:55], s76 offen offset:768
    buffer_load_dwordx4 v[136:139], v2, s[52:55], 0 offen offset:832
    buffer_load_dwordx4 v[140:143], v2, s[52:55], s76 offen offset:832
    ds_read_b64_tr_b16 v[8:9], v7 offset:1536
    ds_read_b64_tr_b16 v[10:11], v7 offset:2304
    s_waitcnt lgkmcnt(8)
    v_mfma_f32_32x32x16_bf16 v[192:207], v[16:19], v[64:67], v[192:207]
    ds_read_b64_tr_b16 v[12:13], v7 offset:1600
    ds_read_b64_tr_b16 v[14:15], v7 offset:2368
    s_waitcnt lgkmcnt(8)
    v_mfma_f32_32x32x16_bf16 v[208:223], v[20:23], v[64:67], v[208:223]
    ds_read_b64_tr_b16 v[16:17], v7 offset:1664
    ds_read_b64_tr_b16 v[18:19], v7 offset:2432
    s_waitcnt lgkmcnt(8)
    v_mfma_f32_32x32x16_bf16 v[224:239], v[24:27], v[64:67], v[224:239]
    ds_read_b64_tr_b16 v[20:21], v7 offset:7680
    ds_read_b64_tr_b16 v[22:23], v7 offset:8448
    ds_write_b128 v0, v[72:75] offset:0
    ds_write_b128 v0, v[76:79] offset:1024
    ds_read_b128 v[72:75], v1 offset:0
    ds_read_b128 v[76:79], v1 offset:16
    s_waitcnt lgkmcnt(12)
    v_mfma_f32_32x32x16_bf16 v[240:255], v[28:31], v[64:67], v[240:255]
    ds_read_b64_tr_b16 v[24:25], v7 offset:7744
    ds_read_b64_tr_b16 v[26:27], v7 offset:8512
    s_waitcnt lgkmcnt(12)
    v_mfma_f32_32x32x16_bf16 v[160:175], v[8:11], v[68:71], v[160:175]
    ds_read_b64_tr_b16 v[28:29], v7 offset:7808
    ds_read_b64_tr_b16 v[30:31], v7 offset:8576
    s_waitcnt lgkmcnt(12)
    v_mfma_f32_32x32x16_bf16 v[176:191], v[12:15], v[68:71], v[176:191]
    ds_read_b64_tr_b16 v[8:9], v7 offset:12288
    ds_read_b64_tr_b16 v[10:11], v7 offset:13056
    s_waitcnt lgkmcnt(12)
    v_mfma_f32_32x32x16_bf16 v[192:207], v[16:19], v[68:71], v[192:207]
    ds_read_b64_tr_b16 v[12:13], v7 offset:12352
    ds_read_b64_tr_b16 v[14:15], v7 offset:13120
    s_waitcnt lgkmcnt(12)
    v_mfma_f32_32x32x16_bf16 v[208:223], v[20:23], v[68:71], v[208:223]
    ds_read_b64_tr_b16 v[16:17], v7 offset:12416
    ds_read_b64_tr_b16 v[18:19], v7 offset:13184
    s_waitcnt lgkmcnt(8)
    v_mfma_f32_32x32x16_bf16 v[224:239], v[24:27], v[68:71], v[224:239]
    ds_read_b64_tr_b16 v[20:21], v7 offset:18432
    ds_read_b64_tr_b16 v[22:23], v7 offset:19200
    s_waitcnt lgkmcnt(8)
    v_mfma_f32_32x32x16_bf16 v[240:255], v[28:31], v[68:71], v[240:255]
    ds_read_b64_tr_b16 v[24:25], v7 offset:18496
    ds_read_b64_tr_b16 v[26:27], v7 offset:19264
    s_waitcnt lgkmcnt(8)
    v_mfma_f32_32x32x16_bf16 v[160:175], v[8:11], v[72:75], v[160:175]
    ds_read_b64_tr_b16 v[28:29], v7 offset:18560
    ds_read_b64_tr_b16 v[30:31], v7 offset:19328
    s_waitcnt lgkmcnt(8)
    v_mfma_f32_32x32x16_bf16 v[176:191], v[12:15], v[72:75], v[176:191]
    s_waitcnt vmcnt(17)
    s_barrier
    s_mov_b32 s50, 880640
    s_add_u32 m0, s51, 49152
    s_nop 0
    buffer_load_dwordx4 v3, s[56:59], s50 offen lds
    s_add_u32 m0, s51, 50176
    s_nop 0
    buffer_load_dwordx4 v4, s[56:59], s50 offen lds
    s_add_u32 m0, s51, 51200
    s_nop 0
    buffer_load_dwordx4 v5, s[56:59], s50 offen lds
    ds_read_b64_tr_b16 v[8:9], v7 offset:13824
    ds_read_b64_tr_b16 v[10:11], v7 offset:14592
    s_waitcnt lgkmcnt(8)
    v_mfma_f32_32x32x16_bf16 v[192:207], v[16:19], v[72:75], v[192:207]
    ds_read_b64_tr_b16 v[12:13], v7 offset:13888
    ds_read_b64_tr_b16 v[14:15], v7 offset:14656
    s_waitcnt lgkmcnt(8)
    v_mfma_f32_32x32x16_bf16 v[208:223], v[20:23], v[72:75], v[208:223]
    ds_read_b64_tr_b16 v[16:17], v7 offset:13952
    ds_read_b64_tr_b16 v[18:19], v7 offset:14720
    s_waitcnt lgkmcnt(8)
    v_mfma_f32_32x32x16_bf16 v[224:239], v[24:27], v[72:75], v[224:239]
    ds_read_b64_tr_b16 v[20:21], v7 offset:19968
    ds_read_b64_tr_b16 v[22:23], v7 offset:20736
    ds_write_b128 v0, v[80:83] offset:0
    ds_write_b128 v0, v[84:87] offset:1024
    ds_read_b128 v[80:83], v1 offset:0
    ds_read_b128 v[84:87], v1 offset:16
    s_waitcnt lgkmcnt(12)
    v_mfma_f32_32x32x16_bf16 v[240:255], v[28:31], v[72:75], v[240:255]
    ds_read_b64_tr_b16 v[24:25], v7 offset:20032
    ds_read_b64_tr_b16 v[26:27], v7 offset:20800
    s_waitcnt lgkmcnt(12)
    v_mfma_f32_32x32x16_bf16 v[160:175], v[8:11], v[76:79], v[160:175]
    ds_read_b64_tr_b16 v[28:29], v7 offset:20096
    ds_read_b64_tr_b16 v[30:31], v7 offset:20864
    s_waitcnt lgkmcnt(12)
    v_mfma_f32_32x32x16_bf16 v[176:191], v[12:15], v[76:79], v[176:191]
    ds_read_b64_tr_b16 v[8:9], v6 offset:0
    ds_read_b64_tr_b16 v[10:11], v6 offset:768
    s_waitcnt lgkmcnt(12)
    v_mfma_f32_32x32x16_bf16 v[192:207], v[16:19], v[76:79], v[192:207]
    ds_read_b64_tr_b16 v[12:13], v6 offset:64
    ds_read_b64_tr_b16 v[14:15], v6 offset:832
    s_waitcnt lgkmcnt(12)
    v_mfma_f32_32x32x16_bf16 v[208:223], v[20:23], v[76:79], v[208:223]
    ds_read_b64_tr_b16 v[16:17], v6 offset:128
    ds_read_b64_tr_b16 v[18:19], v6 offset:896
    s_waitcnt lgkmcnt(8)
    v_mfma_f32_32x32x16_bf16 v[224:239], v[24:27], v[76:79], v[224:239]
    ds_read_b64_tr_b16 v[20:21], v6 offset:6144
    ds_read_b64_tr_b16 v[22:23], v6 offset:6912
    s_waitcnt lgkmcnt(8)
    v_mfma_f32_32x32x16_bf16 v[240:255], v[28:31], v[76:79], v[240:255]
    ds_read_b64_tr_b16 v[24:25], v6 offset:6208
    ds_read_b64_tr_b16 v[26:27], v6 offset:6976
    s_waitcnt lgkmcnt(8)
    v_mfma_f32_32x32x16_bf16 v[160:175], v[8:11], v[80:83], v[160:175]
    ds_read_b64_tr_b16 v[28:29], v6 offset:6272
    ds_read_b64_tr_b16 v[30:31], v6 offset:7040
    s_waitcnt lgkmcnt(8)
    v_mfma_f32_32x32x16_bf16 v[176:191], v[12:15], v[80:83], v[176:191]
    s_waitcnt vmcnt(17)
    s_barrier
    s_mov_b32 s50, 968704
    s_add_u32 m0, s51, 61440
    s_nop 0
    buffer_load_dwordx4 v3, s[56:59], s50 offen lds
    s_add_u32 m0, s51, 62464
    s_nop 0
    buffer_load_dwordx4 v4, s[56:59], s50 offen lds
    s_add_u32 m0, s51, 63488
    s_nop 0
    buffer_load_dwordx4 v5, s[56:59], s50 offen lds
    buffer_load_dwordx4 v[144:147], v2, s[52:55], 0 offen offset:896
    buffer_load_dwordx4 v[148:151], v2, s[52:55], s76 offen offset:896
    buffer_load_dwordx4 v[152:155], v2, s[52:55], 0 offen offset:960
    buffer_load_dwordx4 v[156:159], v2, s[52:55], s76 offen offset:960
    ds_read_b64_tr_b16 v[8:9], v6 offset:1536
    ds_read_b64_tr_b16 v[10:11], v6 offset:2304
    s_waitcnt lgkmcnt(8)
    v_mfma_f32_32x32x16_bf16 v[192:207], v[16:19], v[80:83], v[192:207]
    ds_read_b64_tr_b16 v[12:13], v6 offset:1600
    ds_read_b64_tr_b16 v[14:15], v6 offset:2368
    s_waitcnt lgkmcnt(8)
    v_mfma_f32_32x32x16_bf16 v[208:223], v[20:23], v[80:83], v[208:223]
    ds_read_b64_tr_b16 v[16:17], v6 offset:1664
    ds_read_b64_tr_b16 v[18:19], v6 offset:2432
    s_waitcnt lgkmcnt(8)
    v_mfma_f32_32x32x16_bf16 v[224:239], v[24:27], v[80:83], v[224:239]
    ds_read_b64_tr_b16 v[20:21], v6 offset:7680
    ds_read_b64_tr_b16 v[22:23], v6 offset:8448
    ds_write_b128 v0, v[88:91] offset:0
    ds_write_b128 v0, v[92:95] offset:1024
    ds_read_b128 v[88:91], v1 offset:0
    ds_read_b128 v[92:95], v1 offset:16
    s_waitcnt lgkmcnt(12)
    v_mfma_f32_32x32x16_bf16 v[240:255], v[28:31], v[80:83], v[240:255]
    ds_read_b64_tr_b16 v[24:25], v6 offset:7744
    ds_read_b64_tr_b16 v[26:27], v6 offset:8512
    s_waitcnt lgkmcnt(12)
    v_mfma_f32_32x32x16_bf16 v[160:175], v[8:11], v[84:87], v[160:175]
    ds_read_b64_tr_b16 v[28:29], v6 offset:7808
    ds_read_b64_tr_b16 v[30:31], v6 offset:8576
    s_waitcnt lgkmcnt(12)
    v_mfma_f32_32x32x16_bf16 v[176:191], v[12:15], v[84:87], v[176:191]
    ds_read_b64_tr_b16 v[8:9], v6 offset:12288
    ds_read_b64_tr_b16 v[10:11], v6 offset:13056
    s_waitcnt lgkmcnt(12)
    v_mfma_f32_32x32x16_bf16 v[192:207], v[16:19], v[84:87], v[192:207]
    ds_read_b64_tr_b16 v[12:13], v6 offset:12352
    ds_read_b64_tr_b16 v[14:15], v6 offset:13120
    s_waitcnt lgkmcnt(12)
    v_mfma_f32_32x32x16_bf16 v[208:223], v[20:23], v[84:87], v[208:223]
    ds_read_b64_tr_b16 v[16:17], v6 offset:12416
    ds_read_b64_tr_b16 v[18:19], v6 offset:13184
    s_waitcnt lgkmcnt(8)
    v_mfma_f32_32x32x16_bf16 v[224:239], v[24:27], v[84:87], v[224:239]
    ds_read_b64_tr_b16 v[20:21], v6 offset:18432
    ds_read_b64_tr_b16 v[22:23], v6 offset:19200
    s_waitcnt lgkmcnt(8)
    v_mfma_f32_32x32x16_bf16 v[240:255], v[28:31], v[84:87], v[240:255]
    ds_read_b64_tr_b16 v[24:25], v6 offset:18496
    ds_read_b64_tr_b16 v[26:27], v6 offset:19264
    s_waitcnt lgkmcnt(8)
    v_mfma_f32_32x32x16_bf16 v[160:175], v[8:11], v[88:91], v[160:175]
    ds_read_b64_tr_b16 v[28:29], v6 offset:18560
    ds_read_b64_tr_b16 v[30:31], v6 offset:19328
    s_waitcnt lgkmcnt(8)
    v_mfma_f32_32x32x16_bf16 v[176:191], v[12:15], v[88:91], v[176:191]
    s_waitcnt vmcnt(17)
    s_barrier
    s_mov_b32 s50, 1056768
    s_add_u32 m0, s51, 0
    s_nop 0
    buffer_load_dwordx4 v3, s[56:59], s50 offen lds
    s_add_u32 m0, s51, 1024
    s_nop 0
    buffer_load_dwordx4 v4, s[56:59], s50 offen lds
    s_add_u32 m0, s51, 2048
    s_nop 0
    buffer_load_dwordx4 v5, s[56:59], s50 offen lds
    ds_read_b64_tr_b16 v[8:9], v6 offset:13824
    ds_read_b64_tr_b16 v[10:11], v6 offset:14592
    s_waitcnt lgkmcnt(8)
    v_mfma_f32_32x32x16_bf16 v[192:207], v[16:19], v[88:91], v[192:207]
    ds_read_b64_tr_b16 v[12:13], v6 offset:13888
    ds_read_b64_tr_b16 v[14:15], v6 offset:14656
    s_waitcnt lgkmcnt(8)
    v_mfma_f32_32x32x16_bf16 v[208:223], v[20:23], v[88:91], v[208:223]
    ds_read_b64_tr_b16 v[16:17], v6 offset:13952
    ds_read_b64_tr_b16 v[18:19], v6 offset:14720
    s_waitcnt lgkmcnt(8)
    v_mfma_f32_32x32x16_bf16 v[224:239], v[24:27], v[88:91], v[224:239]
    ds_read_b64_tr_b16 v[20:21], v6 offset:19968
    ds_read_b64_tr_b16 v[22:23], v6 offset:20736
    ds_write_b128 v0, v[96:99] offset:0
    ds_write_b128 v0, v[100:103] offset:1024
    ds_read_b128 v[96:99], v1 offset:0
    ds_read_b128 v[100:103], v1 offset:16
    s_waitcnt lgkmcnt(12)
    v_mfma_f32_32x32x16_bf16 v[240:255], v[28:31], v[88:91], v[240:255]
    ds_read_b64_tr_b16 v[24:25], v6 offset:20032
    ds_read_b64_tr_b16 v[26:27], v6 offset:20800
    s_waitcnt lgkmcnt(12)
    v_mfma_f32_32x32x16_bf16 v[160:175], v[8:11], v[92:95], v[160:175]
    ds_read_b64_tr_b16 v[28:29], v6 offset:20096
    ds_read_b64_tr_b16 v[30:31], v6 offset:20864
    s_waitcnt lgkmcnt(12)
    v_mfma_f32_32x32x16_bf16 v[176:191], v[12:15], v[92:95], v[176:191]
    ds_read_b64_tr_b16 v[8:9], v6 offset:24576
    ds_read_b64_tr_b16 v[10:11], v6 offset:25344
    s_waitcnt lgkmcnt(12)
    v_mfma_f32_32x32x16_bf16 v[192:207], v[16:19], v[92:95], v[192:207]
    ds_read_b64_tr_b16 v[12:13], v6 offset:24640
    ds_read_b64_tr_b16 v[14:15], v6 offset:25408
    s_waitcnt lgkmcnt(12)
    v_mfma_f32_32x32x16_bf16 v[208:223], v[20:23], v[92:95], v[208:223]
    ds_read_b64_tr_b16 v[16:17], v6 offset:24704
    ds_read_b64_tr_b16 v[18:19], v6 offset:25472
    s_waitcnt lgkmcnt(8)
    v_mfma_f32_32x32x16_bf16 v[224:239], v[24:27], v[92:95], v[224:239]
    ds_read_b64_tr_b16 v[20:21], v6 offset:30720
    ds_read_b64_tr_b16 v[22:23], v6 offset:31488
    s_waitcnt lgkmcnt(8)
    v_mfma_f32_32x32x16_bf16 v[240:255], v[28:31], v[92:95], v[240:255]
    ds_read_b64_tr_b16 v[24:25], v6 offset:30784
    ds_read_b64_tr_b16 v[26:27], v6 offset:31552
    s_waitcnt lgkmcnt(8)
    v_mfma_f32_32x32x16_bf16 v[160:175], v[8:11], v[96:99], v[160:175]
    ds_read_b64_tr_b16 v[28:29], v6 offset:30848
    ds_read_b64_tr_b16 v[30:31], v6 offset:31616
    s_waitcnt lgkmcnt(8)
    v_mfma_f32_32x32x16_bf16 v[176:191], v[12:15], v[96:99], v[176:191]
    s_waitcnt vmcnt(17)
    s_barrier
    s_mov_b32 s50, 1144832
    s_add_u32 m0, s51, 12288
    s_nop 0
    buffer_load_dwordx4 v3, s[56:59], s50 offen lds
    s_add_u32 m0, s51, 13312
    s_nop 0
    buffer_load_dwordx4 v4, s[56:59], s50 offen lds
    s_add_u32 m0, s51, 14336
    s_nop 0
    buffer_load_dwordx4 v5, s[56:59], s50 offen lds
    ds_read_b64_tr_b16 v[8:9], v6 offset:26112
    ds_read_b64_tr_b16 v[10:11], v6 offset:26880
    s_waitcnt lgkmcnt(8)
    v_mfma_f32_32x32x16_bf16 v[192:207], v[16:19], v[96:99], v[192:207]
    ds_read_b64_tr_b16 v[12:13], v6 offset:26176
    ds_read_b64_tr_b16 v[14:15], v6 offset:26944
    s_waitcnt lgkmcnt(8)
    v_mfma_f32_32x32x16_bf16 v[208:223], v[20:23], v[96:99], v[208:223]
    ds_read_b64_tr_b16 v[16:17], v6 offset:26240
    ds_read_b64_tr_b16 v[18:19], v6 offset:27008
    s_waitcnt lgkmcnt(8)
    v_mfma_f32_32x32x16_bf16 v[224:239], v[24:27], v[96:99], v[224:239]
    ds_read_b64_tr_b16 v[20:21], v6 offset:32256
    ds_read_b64_tr_b16 v[22:23], v6 offset:33024
    ds_write_b128 v0, v[104:107] offset:0
    ds_write_b128 v0, v[108:111] offset:1024
    ds_read_b128 v[104:107], v1 offset:0
    ds_read_b128 v[108:111], v1 offset:16
    s_waitcnt lgkmcnt(12)
    v_mfma_f32_32x32x16_bf16 v[240:255], v[28:31], v[96:99], v[240:255]
    ds_read_b64_tr_b16 v[24:25], v6 offset:32320
    ds_read_b64_tr_b16 v[26:27], v6 offset:33088
    s_waitcnt lgkmcnt(12)
    v_mfma_f32_32x32x16_bf16 v[160:175], v[8:11], v[100:103], v[160:175]
    ds_read_b64_tr_b16 v[28:29], v6 offset:32384
    ds_read_b64_tr_b16 v[30:31], v6 offset:33152
    s_waitcnt lgkmcnt(12)
    v_mfma_f32_32x32x16_bf16 v[176:191], v[12:15], v[100:103], v[176:191]
    ds_read_b64_tr_b16 v[8:9], v6 offset:36864
    ds_read_b64_tr_b16 v[10:11], v6 offset:37632
    s_waitcnt lgkmcnt(12)
    v_mfma_f32_32x32x16_bf16 v[192:207], v[16:19], v[100:103], v[192:207]
    ds_read_b64_tr_b16 v[12:13], v6 offset:36928
    ds_read_b64_tr_b16 v[14:15], v6 offset:37696
    s_waitcnt lgkmcnt(12)
    v_mfma_f32_32x32x16_bf16 v[208:223], v[20:23], v[100:103], v[208:223]
    ds_read_b64_tr_b16 v[16:17], v6 offset:36992
    ds_read_b64_tr_b16 v[18:19], v6 offset:37760
    s_waitcnt lgkmcnt(8)
    v_mfma_f32_32x32x16_bf16 v[224:239], v[24:27], v[100:103], v[224:239]
    ds_read_b64_tr_b16 v[20:21], v6 offset:43008
    ds_read_b64_tr_b16 v[22:23], v6 offset:43776
    s_waitcnt lgkmcnt(8)
    v_mfma_f32_32x32x16_bf16 v[240:255], v[28:31], v[100:103], v[240:255]
    ds_read_b64_tr_b16 v[24:25], v6 offset:43072
    ds_read_b64_tr_b16 v[26:27], v6 offset:43840
    s_waitcnt lgkmcnt(8)
    v_mfma_f32_32x32x16_bf16 v[160:175], v[8:11], v[104:107], v[160:175]
    ds_read_b64_tr_b16 v[28:29], v6 offset:43136
    ds_read_b64_tr_b16 v[30:31], v6 offset:43904
    s_waitcnt lgkmcnt(8)
    v_mfma_f32_32x32x16_bf16 v[176:191], v[12:15], v[104:107], v[176:191]
    s_waitcnt vmcnt(13)
    s_barrier
    s_mov_b32 s50, 1232896
    s_add_u32 m0, s51, 24576
    s_nop 0
    buffer_load_dwordx4 v3, s[56:59], s50 offen lds
    s_add_u32 m0, s51, 25600
    s_nop 0
    buffer_load_dwordx4 v4, s[56:59], s50 offen lds
    s_add_u32 m0, s51, 26624
    s_nop 0
    buffer_load_dwordx4 v5, s[56:59], s50 offen lds
    ds_read_b64_tr_b16 v[8:9], v6 offset:38400
    ds_read_b64_tr_b16 v[10:11], v6 offset:39168
    s_waitcnt lgkmcnt(8)
    v_mfma_f32_32x32x16_bf16 v[192:207], v[16:19], v[104:107], v[192:207]
    ds_read_b64_tr_b16 v[12:13], v6 offset:38464
    ds_read_b64_tr_b16 v[14:15], v6 offset:39232
    s_waitcnt lgkmcnt(8)
    v_mfma_f32_32x32x16_bf16 v[208:223], v[20:23], v[104:107], v[208:223]
    ds_read_b64_tr_b16 v[16:17], v6 offset:38528
    ds_read_b64_tr_b16 v[18:19], v6 offset:39296
    s_waitcnt lgkmcnt(8)
    v_mfma_f32_32x32x16_bf16 v[224:239], v[24:27], v[104:107], v[224:239]
    ds_read_b64_tr_b16 v[20:21], v6 offset:44544
    ds_read_b64_tr_b16 v[22:23], v6 offset:45312
    ds_write_b128 v0, v[112:115] offset:0
    ds_write_b128 v0, v[116:119] offset:1024
    ds_read_b128 v[112:115], v1 offset:0
    ds_read_b128 v[116:119], v1 offset:16
    s_waitcnt lgkmcnt(12)
    v_mfma_f32_32x32x16_bf16 v[240:255], v[28:31], v[104:107], v[240:255]
    ds_read_b64_tr_b16 v[24:25], v6 offset:44608
    ds_read_b64_tr_b16 v[26:27], v6 offset:45376
    s_waitcnt lgkmcnt(12)
    v_mfma_f32_32x32x16_bf16 v[160:175], v[8:11], v[108:111], v[160:175]
    ds_read_b64_tr_b16 v[28:29], v6 offset:44672
    ds_read_b64_tr_b16 v[30:31], v6 offset:45440
    s_waitcnt lgkmcnt(12)
    v_mfma_f32_32x32x16_bf16 v[176:191], v[12:15], v[108:111], v[176:191]
    ds_read_b64_tr_b16 v[8:9], v7 offset:0
    ds_read_b64_tr_b16 v[10:11], v7 offset:768
    s_waitcnt lgkmcnt(12)
    v_mfma_f32_32x32x16_bf16 v[192:207], v[16:19], v[108:111], v[192:207]
    ds_read_b64_tr_b16 v[12:13], v7 offset:64
    ds_read_b64_tr_b16 v[14:15], v7 offset:832
    s_waitcnt lgkmcnt(12)
    v_mfma_f32_32x32x16_bf16 v[208:223], v[20:23], v[108:111], v[208:223]
    ds_read_b64_tr_b16 v[16:17], v7 offset:128
    ds_read_b64_tr_b16 v[18:19], v7 offset:896
    s_waitcnt lgkmcnt(8)
    v_mfma_f32_32x32x16_bf16 v[224:239], v[24:27], v[108:111], v[224:239]
    ds_read_b64_tr_b16 v[20:21], v7 offset:6144
    ds_read_b64_tr_b16 v[22:23], v7 offset:6912
    s_waitcnt lgkmcnt(8)
    v_mfma_f32_32x32x16_bf16 v[240:255], v[28:31], v[108:111], v[240:255]
    ds_read_b64_tr_b16 v[24:25], v7 offset:6208
    ds_read_b64_tr_b16 v[26:27], v7 offset:6976
    s_waitcnt lgkmcnt(8)
    v_mfma_f32_32x32x16_bf16 v[160:175], v[8:11], v[112:115], v[160:175]
    ds_read_b64_tr_b16 v[28:29], v7 offset:6272
    ds_read_b64_tr_b16 v[30:31], v7 offset:7040
    s_waitcnt lgkmcnt(8)
    v_mfma_f32_32x32x16_bf16 v[176:191], v[12:15], v[112:115], v[176:191]
    s_waitcnt vmcnt(13)
    s_barrier
    s_mov_b32 s50, 1320960
    s_add_u32 m0, s51, 36864
    s_nop 0
    buffer_load_dwordx4 v3, s[56:59], s50 offen lds
    s_add_u32 m0, s51, 37888
    s_nop 0
    buffer_load_dwordx4 v4, s[56:59], s50 offen lds
    s_add_u32 m0, s51, 38912
    s_nop 0
    buffer_load_dwordx4 v5, s[56:59], s50 offen lds
    ds_read_b64_tr_b16 v[8:9], v7 offset:1536
    ds_read_b64_tr_b16 v[10:11], v7 offset:2304
    s_waitcnt lgkmcnt(8)
    v_mfma_f32_32x32x16_bf16 v[192:207], v[16:19], v[112:115], v[192:207]
    ds_read_b64_tr_b16 v[12:13], v7 offset:1600
    ds_read_b64_tr_b16 v[14:15], v7 offset:2368
    s_waitcnt lgkmcnt(8)
    v_mfma_f32_32x32x16_bf16 v[208:223], v[20:23], v[112:115], v[208:223]
    ds_read_b64_tr_b16 v[16:17], v7 offset:1664
    ds_read_b64_tr_b16 v[18:19], v7 offset:2432
    s_waitcnt lgkmcnt(8)
    v_mfma_f32_32x32x16_bf16 v[224:239], v[24:27], v[112:115], v[224:239]
    ds_read_b64_tr_b16 v[20:21], v7 offset:7680
    ds_read_b64_tr_b16 v[22:23], v7 offset:8448
    ds_write_b128 v0, v[120:123] offset:0
    ds_write_b128 v0, v[124:127] offset:1024
    ds_read_b128 v[120:123], v1 offset:0
    ds_read_b128 v[124:127], v1 offset:16
    s_waitcnt lgkmcnt(12)
    v_mfma_f32_32x32x16_bf16 v[240:255], v[28:31], v[112:115], v[240:255]
    ds_read_b64_tr_b16 v[24:25], v7 offset:7744
    ds_read_b64_tr_b16 v[26:27], v7 offset:8512
    s_waitcnt lgkmcnt(12)
    v_mfma_f32_32x32x16_bf16 v[160:175], v[8:11], v[116:119], v[160:175]
    ds_read_b64_tr_b16 v[28:29], v7 offset:7808
    ds_read_b64_tr_b16 v[30:31], v7 offset:8576
    s_waitcnt lgkmcnt(12)
    v_mfma_f32_32x32x16_bf16 v[176:191], v[12:15], v[116:119], v[176:191]
    ds_read_b64_tr_b16 v[8:9], v7 offset:12288
    ds_read_b64_tr_b16 v[10:11], v7 offset:13056
    s_waitcnt lgkmcnt(12)
    v_mfma_f32_32x32x16_bf16 v[192:207], v[16:19], v[116:119], v[192:207]
    ds_read_b64_tr_b16 v[12:13], v7 offset:12352
    ds_read_b64_tr_b16 v[14:15], v7 offset:13120
    s_waitcnt lgkmcnt(12)
    v_mfma_f32_32x32x16_bf16 v[208:223], v[20:23], v[116:119], v[208:223]
    ds_read_b64_tr_b16 v[16:17], v7 offset:12416
    ds_read_b64_tr_b16 v[18:19], v7 offset:13184
    s_waitcnt lgkmcnt(8)
    v_mfma_f32_32x32x16_bf16 v[224:239], v[24:27], v[116:119], v[224:239]
    ds_read_b64_tr_b16 v[20:21], v7 offset:18432
    ds_read_b64_tr_b16 v[22:23], v7 offset:19200
    s_waitcnt lgkmcnt(8)
    v_mfma_f32_32x32x16_bf16 v[240:255], v[28:31], v[116:119], v[240:255]
    ds_read_b64_tr_b16 v[24:25], v7 offset:18496
    ds_read_b64_tr_b16 v[26:27], v7 offset:19264
    s_waitcnt lgkmcnt(8)
    v_mfma_f32_32x32x16_bf16 v[160:175], v[8:11], v[120:123], v[160:175]
    ds_read_b64_tr_b16 v[28:29], v7 offset:18560
    ds_read_b64_tr_b16 v[30:31], v7 offset:19328
    s_waitcnt lgkmcnt(8)
    v_mfma_f32_32x32x16_bf16 v[176:191], v[12:15], v[120:123], v[176:191]
    s_waitcnt vmcnt(9)
    s_barrier
    ds_read_b64_tr_b16 v[8:9], v7 offset:13824
    ds_read_b64_tr_b16 v[10:11], v7 offset:14592
    s_waitcnt lgkmcnt(8)
    v_mfma_f32_32x32x16_bf16 v[192:207], v[16:19], v[120:123], v[192:207]
    ds_read_b64_tr_b16 v[12:13], v7 offset:13888
    ds_read_b64_tr_b16 v[14:15], v7 offset:14656
    s_waitcnt lgkmcnt(8)
    v_mfma_f32_32x32x16_bf16 v[208:223], v[20:23], v[120:123], v[208:223]
    ds_read_b64_tr_b16 v[16:17], v7 offset:13952
    ds_read_b64_tr_b16 v[18:19], v7 offset:14720
    s_waitcnt lgkmcnt(8)
    v_mfma_f32_32x32x16_bf16 v[224:239], v[24:27], v[120:123], v[224:239]
    ds_read_b64_tr_b16 v[20:21], v7 offset:19968
    ds_read_b64_tr_b16 v[22:23], v7 offset:20736
    ds_write_b128 v0, v[128:131] offset:0
    ds_write_b128 v0, v[132:135] offset:1024
    ds_read_b128 v[128:131], v1 offset:0
    ds_read_b128 v[132:135], v1 offset:16
    s_waitcnt lgkmcnt(12)
    v_mfma_f32_32x32x16_bf16 v[240:255], v[28:31], v[120:123], v[240:255]
    ds_read_b64_tr_b16 v[24:25], v7 offset:20032
    ds_read_b64_tr_b16 v[26:27], v7 offset:20800
    s_waitcnt lgkmcnt(12)
    v_mfma_f32_32x32x16_bf16 v[160:175], v[8:11], v[124:127], v[160:175]
    ds_read_b64_tr_b16 v[28:29], v7 offset:20096
    ds_read_b64_tr_b16 v[30:31], v7 offset:20864
    s_waitcnt lgkmcnt(12)
    v_mfma_f32_32x32x16_bf16 v[176:191], v[12:15], v[124:127], v[176:191]
    ds_read_b64_tr_b16 v[8:9], v6 offset:0
    ds_read_b64_tr_b16 v[10:11], v6 offset:768
    s_waitcnt lgkmcnt(12)
    v_mfma_f32_32x32x16_bf16 v[192:207], v[16:19], v[124:127], v[192:207]
    ds_read_b64_tr_b16 v[12:13], v6 offset:64
    ds_read_b64_tr_b16 v[14:15], v6 offset:832
    s_waitcnt lgkmcnt(12)
    v_mfma_f32_32x32x16_bf16 v[208:223], v[20:23], v[124:127], v[208:223]
    ds_read_b64_tr_b16 v[16:17], v6 offset:128
    ds_read_b64_tr_b16 v[18:19], v6 offset:896
    s_waitcnt lgkmcnt(8)
    v_mfma_f32_32x32x16_bf16 v[224:239], v[24:27], v[124:127], v[224:239]
    ds_read_b64_tr_b16 v[20:21], v6 offset:6144
    ds_read_b64_tr_b16 v[22:23], v6 offset:6912
    s_waitcnt lgkmcnt(8)
    v_mfma_f32_32x32x16_bf16 v[240:255], v[28:31], v[124:127], v[240:255]
    ds_read_b64_tr_b16 v[24:25], v6 offset:6208
    ds_read_b64_tr_b16 v[26:27], v6 offset:6976
    s_waitcnt lgkmcnt(8)
    v_mfma_f32_32x32x16_bf16 v[160:175], v[8:11], v[128:131], v[160:175]
    ds_read_b64_tr_b16 v[28:29], v6 offset:6272
    ds_read_b64_tr_b16 v[30:31], v6 offset:7040
    s_waitcnt lgkmcnt(8)
    v_mfma_f32_32x32x16_bf16 v[176:191], v[12:15], v[128:131], v[176:191]
    s_waitcnt vmcnt(6)
    s_barrier
    ds_read_b64_tr_b16 v[8:9], v6 offset:1536
    ds_read_b64_tr_b16 v[10:11], v6 offset:2304
    s_waitcnt lgkmcnt(8)
    v_mfma_f32_32x32x16_bf16 v[192:207], v[16:19], v[128:131], v[192:207]
    ds_read_b64_tr_b16 v[12:13], v6 offset:1600
    ds_read_b64_tr_b16 v[14:15], v6 offset:2368
    s_waitcnt lgkmcnt(8)
    v_mfma_f32_32x32x16_bf16 v[208:223], v[20:23], v[128:131], v[208:223]
    ds_read_b64_tr_b16 v[16:17], v6 offset:1664
    ds_read_b64_tr_b16 v[18:19], v6 offset:2432
    s_waitcnt lgkmcnt(8)
    v_mfma_f32_32x32x16_bf16 v[224:239], v[24:27], v[128:131], v[224:239]
    ds_read_b64_tr_b16 v[20:21], v6 offset:7680
    ds_read_b64_tr_b16 v[22:23], v6 offset:8448
    ds_write_b128 v0, v[136:139] offset:0
    ds_write_b128 v0, v[140:143] offset:1024
    ds_read_b128 v[136:139], v1 offset:0
    ds_read_b128 v[140:143], v1 offset:16
    s_waitcnt lgkmcnt(12)
    v_mfma_f32_32x32x16_bf16 v[240:255], v[28:31], v[128:131], v[240:255]
    ds_read_b64_tr_b16 v[24:25], v6 offset:7744
    ds_read_b64_tr_b16 v[26:27], v6 offset:8512
    s_waitcnt lgkmcnt(12)
    v_mfma_f32_32x32x16_bf16 v[160:175], v[8:11], v[132:135], v[160:175]
    ds_read_b64_tr_b16 v[28:29], v6 offset:7808
    ds_read_b64_tr_b16 v[30:31], v6 offset:8576
    s_waitcnt lgkmcnt(12)
    v_mfma_f32_32x32x16_bf16 v[176:191], v[12:15], v[132:135], v[176:191]
    ds_read_b64_tr_b16 v[8:9], v6 offset:12288
    ds_read_b64_tr_b16 v[10:11], v6 offset:13056
    s_waitcnt lgkmcnt(12)
    v_mfma_f32_32x32x16_bf16 v[192:207], v[16:19], v[132:135], v[192:207]
    ds_read_b64_tr_b16 v[12:13], v6 offset:12352
    ds_read_b64_tr_b16 v[14:15], v6 offset:13120
    s_waitcnt lgkmcnt(12)
    v_mfma_f32_32x32x16_bf16 v[208:223], v[20:23], v[132:135], v[208:223]
    ds_read_b64_tr_b16 v[16:17], v6 offset:12416
    ds_read_b64_tr_b16 v[18:19], v6 offset:13184
    s_waitcnt lgkmcnt(8)
    v_mfma_f32_32x32x16_bf16 v[224:239], v[24:27], v[132:135], v[224:239]
    ds_read_b64_tr_b16 v[20:21], v6 offset:18432
    ds_read_b64_tr_b16 v[22:23], v6 offset:19200
    s_waitcnt lgkmcnt(8)
    v_mfma_f32_32x32x16_bf16 v[240:255], v[28:31], v[132:135], v[240:255]
    ds_read_b64_tr_b16 v[24:25], v6 offset:18496
    ds_read_b64_tr_b16 v[26:27], v6 offset:19264
    s_waitcnt lgkmcnt(8)
    v_mfma_f32_32x32x16_bf16 v[160:175], v[8:11], v[136:139], v[160:175]
    ds_read_b64_tr_b16 v[28:29], v6 offset:18560
    ds_read_b64_tr_b16 v[30:31], v6 offset:19328
    s_waitcnt lgkmcnt(8)
    v_mfma_f32_32x32x16_bf16 v[176:191], v[12:15], v[136:139], v[176:191]
    s_waitcnt vmcnt(3)
    s_barrier
    ds_read_b64_tr_b16 v[8:9], v6 offset:13824
    ds_read_b64_tr_b16 v[10:11], v6 offset:14592
    s_waitcnt lgkmcnt(8)
    v_mfma_f32_32x32x16_bf16 v[192:207], v[16:19], v[136:139], v[192:207]
    ds_read_b64_tr_b16 v[12:13], v6 offset:13888
    ds_read_b64_tr_b16 v[14:15], v6 offset:14656
    s_waitcnt lgkmcnt(8)
    v_mfma_f32_32x32x16_bf16 v[208:223], v[20:23], v[136:139], v[208:223]
    ds_read_b64_tr_b16 v[16:17], v6 offset:13952
    ds_read_b64_tr_b16 v[18:19], v6 offset:14720
    s_waitcnt lgkmcnt(8)
    v_mfma_f32_32x32x16_bf16 v[224:239], v[24:27], v[136:139], v[224:239]
    ds_read_b64_tr_b16 v[20:21], v6 offset:19968
    ds_read_b64_tr_b16 v[22:23], v6 offset:20736
    ds_write_b128 v0, v[144:147] offset:0
    ds_write_b128 v0, v[148:151] offset:1024
    ds_read_b128 v[144:147], v1 offset:0
    ds_read_b128 v[148:151], v1 offset:16
    s_waitcnt lgkmcnt(12)
    v_mfma_f32_32x32x16_bf16 v[240:255], v[28:31], v[136:139], v[240:255]
    ds_read_b64_tr_b16 v[24:25], v6 offset:20032
    ds_read_b64_tr_b16 v[26:27], v6 offset:20800
    s_waitcnt lgkmcnt(12)
    v_mfma_f32_32x32x16_bf16 v[160:175], v[8:11], v[140:143], v[160:175]
    ds_read_b64_tr_b16 v[28:29], v6 offset:20096
    ds_read_b64_tr_b16 v[30:31], v6 offset:20864
    s_waitcnt lgkmcnt(12)
    v_mfma_f32_32x32x16_bf16 v[176:191], v[12:15], v[140:143], v[176:191]
    ds_read_b64_tr_b16 v[8:9], v6 offset:24576
    ds_read_b64_tr_b16 v[10:11], v6 offset:25344
    s_waitcnt lgkmcnt(12)
    v_mfma_f32_32x32x16_bf16 v[192:207], v[16:19], v[140:143], v[192:207]
    ds_read_b64_tr_b16 v[12:13], v6 offset:24640
    ds_read_b64_tr_b16 v[14:15], v6 offset:25408
    s_waitcnt lgkmcnt(12)
    v_mfma_f32_32x32x16_bf16 v[208:223], v[20:23], v[140:143], v[208:223]
    ds_read_b64_tr_b16 v[16:17], v6 offset:24704
    ds_read_b64_tr_b16 v[18:19], v6 offset:25472
    s_waitcnt lgkmcnt(8)
    v_mfma_f32_32x32x16_bf16 v[224:239], v[24:27], v[140:143], v[224:239]
    ds_read_b64_tr_b16 v[20:21], v6 offset:30720
    ds_read_b64_tr_b16 v[22:23], v6 offset:31488
    s_waitcnt lgkmcnt(8)
    v_mfma_f32_32x32x16_bf16 v[240:255], v[28:31], v[140:143], v[240:255]
    ds_read_b64_tr_b16 v[24:25], v6 offset:30784
    ds_read_b64_tr_b16 v[26:27], v6 offset:31552
    s_waitcnt lgkmcnt(8)
    v_mfma_f32_32x32x16_bf16 v[160:175], v[8:11], v[144:147], v[160:175]
    ds_read_b64_tr_b16 v[28:29], v6 offset:30848
    ds_read_b64_tr_b16 v[30:31], v6 offset:31616
    s_waitcnt lgkmcnt(8)
    v_mfma_f32_32x32x16_bf16 v[176:191], v[12:15], v[144:147], v[176:191]
    s_waitcnt vmcnt(0)
    s_barrier
    ds_read_b64_tr_b16 v[8:9], v6 offset:26112
    ds_read_b64_tr_b16 v[10:11], v6 offset:26880
    s_waitcnt lgkmcnt(8)
    v_mfma_f32_32x32x16_bf16 v[192:207], v[16:19], v[144:147], v[192:207]
    ds_read_b64_tr_b16 v[12:13], v6 offset:26176
    ds_read_b64_tr_b16 v[14:15], v6 offset:26944
    s_waitcnt lgkmcnt(8)
    v_mfma_f32_32x32x16_bf16 v[208:223], v[20:23], v[144:147], v[208:223]
    ds_read_b64_tr_b16 v[16:17], v6 offset:26240
    ds_read_b64_tr_b16 v[18:19], v6 offset:27008
    s_waitcnt lgkmcnt(8)
    v_mfma_f32_32x32x16_bf16 v[224:239], v[24:27], v[144:147], v[224:239]
    ds_read_b64_tr_b16 v[20:21], v6 offset:32256
    ds_read_b64_tr_b16 v[22:23], v6 offset:33024
    ds_write_b128 v0, v[152:155] offset:0
    ds_write_b128 v0, v[156:159] offset:1024
    ds_read_b128 v[152:155], v1 offset:0
    ds_read_b128 v[156:159], v1 offset:16
    s_waitcnt lgkmcnt(12)
    v_mfma_f32_32x32x16_bf16 v[240:255], v[28:31], v[144:147], v[240:255]
    ds_read_b64_tr_b16 v[24:25], v6 offset:32320
    ds_read_b64_tr_b16 v[26:27], v6 offset:33088
    s_waitcnt lgkmcnt(12)
    v_mfma_f32_32x32x16_bf16 v[160:175], v[8:11], v[148:151], v[160:175]
    ds_read_b64_tr_b16 v[28:29], v6 offset:32384
    ds_read_b64_tr_b16 v[30:31], v6 offset:33152
    s_waitcnt lgkmcnt(12)
    v_mfma_f32_32x32x16_bf16 v[176:191], v[12:15], v[148:151], v[176:191]
    ds_read_b64_tr_b16 v[8:9], v6 offset:36864
    ds_read_b64_tr_b16 v[10:11], v6 offset:37632
    s_waitcnt lgkmcnt(12)
    v_mfma_f32_32x32x16_bf16 v[192:207], v[16:19], v[148:151], v[192:207]
    ds_read_b64_tr_b16 v[12:13], v6 offset:36928
    ds_read_b64_tr_b16 v[14:15], v6 offset:37696
    s_waitcnt lgkmcnt(12)
    v_mfma_f32_32x32x16_bf16 v[208:223], v[20:23], v[148:151], v[208:223]
    ds_read_b64_tr_b16 v[16:17], v6 offset:36992
    ds_read_b64_tr_b16 v[18:19], v6 offset:37760
    s_waitcnt lgkmcnt(8)
    v_mfma_f32_32x32x16_bf16 v[224:239], v[24:27], v[148:151], v[224:239]
    ds_read_b64_tr_b16 v[20:21], v6 offset:43008
    ds_read_b64_tr_b16 v[22:23], v6 offset:43776
    s_waitcnt lgkmcnt(8)
    v_mfma_f32_32x32x16_bf16 v[240:255], v[28:31], v[148:151], v[240:255]
    ds_read_b64_tr_b16 v[24:25], v6 offset:43072
    ds_read_b64_tr_b16 v[26:27], v6 offset:43840
    s_waitcnt lgkmcnt(8)
    v_mfma_f32_32x32x16_bf16 v[160:175], v[8:11], v[152:155], v[160:175]
    ds_read_b64_tr_b16 v[28:29], v6 offset:43136
    ds_read_b64_tr_b16 v[30:31], v6 offset:43904
    s_waitcnt lgkmcnt(8)
    v_mfma_f32_32x32x16_bf16 v[176:191], v[12:15], v[152:155], v[176:191]
    ds_read_b64_tr_b16 v[8:9], v6 offset:38400
    ds_read_b64_tr_b16 v[10:11], v6 offset:39168
    s_waitcnt lgkmcnt(8)
    v_mfma_f32_32x32x16_bf16 v[192:207], v[16:19], v[152:155], v[192:207]
    ds_read_b64_tr_b16 v[12:13], v6 offset:38464
    ds_read_b64_tr_b16 v[14:15], v6 offset:39232
    s_waitcnt lgkmcnt(8)
    v_mfma_f32_32x32x16_bf16 v[208:223], v[20:23], v[152:155], v[208:223]
    ds_read_b64_tr_b16 v[16:17], v6 offset:38528
    ds_read_b64_tr_b16 v[18:19], v6 offset:39296
    s_waitcnt lgkmcnt(8)
    v_mfma_f32_32x32x16_bf16 v[224:239], v[24:27], v[152:155], v[224:239]
    ds_read_b64_tr_b16 v[20:21], v6 offset:44544
    ds_read_b64_tr_b16 v[22:23], v6 offset:45312
    s_waitcnt lgkmcnt(8)
    v_mfma_f32_32x32x16_bf16 v[240:255], v[28:31], v[152:155], v[240:255]
    ds_read_b64_tr_b16 v[24:25], v6 offset:44608
    ds_read_b64_tr_b16 v[26:27], v6 offset:45376
    s_waitcnt lgkmcnt(8)
    v_mfma_f32_32x32x16_bf16 v[160:175], v[8:11], v[156:159], v[160:175]
    ds_read_b64_tr_b16 v[28:29], v6 offset:44672
    ds_read_b64_tr_b16 v[30:31], v6 offset:45440
    s_waitcnt lgkmcnt(8)
    v_mfma_f32_32x32x16_bf16 v[176:191], v[12:15], v[156:159], v[176:191]
    s_waitcnt lgkmcnt(6)
    v_mfma_f32_32x32x16_bf16 v[192:207], v[16:19], v[156:159], v[192:207]
    s_waitcnt lgkmcnt(4)
    v_mfma_f32_32x32x16_bf16 v[208:223], v[20:23], v[156:159], v[208:223]
    s_waitcnt lgkmcnt(2)
    v_mfma_f32_32x32x16_bf16 v[224:239], v[24:27], v[156:159], v[224:239]
    s_waitcnt lgkmcnt(0)
    v_mfma_f32_32x32x16_bf16 v[240:255], v[28:31], v[156:159], v[240:255]
    s_setprio 0
    s_mov_b32 s70, 0xc0135761
    s_mov_b32 s71, 0xc0135761
    s_mov_b32 s72, 0x3d372713
    s_mov_b32 s73, 0x3d372713
    s_lshl_b32 s50, s47, 2
    s_add_u32 s50, s50, s49
    s_mul_i32 s50, s50, 43
    s_mul_i32 s51, s48, 3
    s_add_u32 s50, s50, s51
    s_lshl_b32 s50, s50, 11
    v_mbcnt_lo_u32_b32 v1, -1, 0
    v_mbcnt_hi_u32_b32 v1, -1, v1
    v_lshlrev_b32 v2, 4, v1
    v_cvt_pk_bf16_f32 v8, v160, v161
    v_cvt_pk_bf16_f32 v9, v208, v209
    v_lshlrev_b32 v10, 16, v8
    v_and_b32 v11, 0xffff0000, v8
    v_lshlrev_b32 v12, 16, v9
    v_and_b32 v13, 0xffff0000, v9
    v_pk_mul_f32 v[14:15], v[10:11], v[10:11]
    v_pk_fma_f32 v[14:15], v[14:15], s[72:73], 1.0 op_sel_hi:[1,1,0]
    v_pk_mul_f32 v[14:15], v[14:15], v[10:11]
    v_pk_mul_f32 v[14:15], v[14:15], s[70:71]
    v_exp_f32 v14, v14
    v_exp_f32 v15, v15
    s_nop 0
    v_pk_add_f32 v[14:15], v[14:15], 1.0 op_sel_hi:[1,0]
    v_rcp_f32 v14, v14
    v_rcp_f32 v15, v15
    s_nop 0
    v_pk_mul_f32 v[14:15], v[14:15], v[10:11]
    v_cvt_pk_bf16_f32 v8, v14, v15
    v_lshlrev_b32 v14, 16, v8
    v_and_b32 v15, 0xffff0000, v8
    v_pk_mul_f32 v[14:15], v[14:15], v[12:13]
    v_cvt_pk_bf16_f32 v32, v14, v15
    v_cvt_pk_bf16_f32 v8, v162, v163
    v_cvt_pk_bf16_f32 v9, v210, v211
    v_lshlrev_b32 v10, 16, v8
    v_and_b32 v11, 0xffff0000, v8
    v_lshlrev_b32 v12, 16, v9
    v_and_b32 v13, 0xffff0000, v9
    v_pk_mul_f32 v[14:15], v[10:11], v[10:11]
    v_pk_fma_f32 v[14:15], v[14:15], s[72:73], 1.0 op_sel_hi:[1,1,0]
    v_pk_mul_f32 v[14:15], v[14:15], v[10:11]
    v_pk_mul_f32 v[14:15], v[14:15], s[70:71]
    v_exp_f32 v14, v14
    v_exp_f32 v15, v15
    s_nop 0
    v_pk_add_f32 v[14:15], v[14:15], 1.0 op_sel_hi:[1,0]
    v_rcp_f32 v14, v14
    v_rcp_f32 v15, v15
    s_nop 0
    v_pk_mul_f32 v[14:15], v[14:15], v[10:11]
    v_cvt_pk_bf16_f32 v8, v14, v15
    v_lshlrev_b32 v14, 16, v8
    v_and_b32 v15, 0xffff0000, v8
    v_pk_mul_f32 v[14:15], v[14:15], v[12:13]
    v_cvt_pk_bf16_f32 v33, v14, v15
    v_cvt_pk_bf16_f32 v8, v164, v165
    v_cvt_pk_bf16_f32 v9, v212, v213
    v_lshlrev_b32 v10, 16, v8
    v_and_b32 v11, 0xffff0000, v8
    v_lshlrev_b32 v12, 16, v9
    v_and_b32 v13, 0xffff0000, v9
    v_pk_mul_f32 v[14:15], v[10:11], v[10:11]
    v_pk_fma_f32 v[14:15], v[14:15], s[72:73], 1.0 op_sel_hi:[1,1,0]
    v_pk_mul_f32 v[14:15], v[14:15], v[10:11]
    v_pk_mul_f32 v[14:15], v[14:15], s[70:71]
    v_exp_f32 v14, v14
    v_exp_f32 v15, v15
    s_nop 0
    v_pk_add_f32 v[14:15], v[14:15], 1.0 op_sel_hi:[1,0]
    v_rcp_f32 v14, v14
    v_rcp_f32 v15, v15
    s_nop 0
    v_pk_mul_f32 v[14:15], v[14:15], v[10:11]
    v_cvt_pk_bf16_f32 v8, v14, v15
    v_lshlrev_b32 v14, 16, v8
    v_and_b32 v15, 0xffff0000, v8
    v_pk_mul_f32 v[14:15], v[14:15], v[12:13]
    v_cvt_pk_bf16_f32 v34, v14, v15
    v_cvt_pk_bf16_f32 v8, v166, v167
    v_cvt_pk_bf16_f32 v9, v214, v215
    v_lshlrev_b32 v10, 16, v8
    v_and_b32 v11, 0xffff0000, v8
    v_lshlrev_b32 v12, 16, v9
    v_and_b32 v13, 0xffff0000, v9
    v_pk_mul_f32 v[14:15], v[10:11], v[10:11]
    v_pk_fma_f32 v[14:15], v[14:15], s[72:73], 1.0 op_sel_hi:[1,1,0]
    v_pk_mul_f32 v[14:15], v[14:15], v[10:11]
    v_pk_mul_f32 v[14:15], v[14:15], s[70:71]
    v_exp_f32 v14, v14
    v_exp_f32 v15, v15
    s_nop 0
    v_pk_add_f32 v[14:15], v[14:15], 1.0 op_sel_hi:[1,0]
    v_rcp_f32 v14, v14
    v_rcp_f32 v15, v15
    s_nop 0
    v_pk_mul_f32 v[14:15], v[14:15], v[10:11]
    v_cvt_pk_bf16_f32 v8, v14, v15
    v_lshlrev_b32 v14, 16, v8
    v_and_b32 v15, 0xffff0000, v8
    v_pk_mul_f32 v[14:15], v[14:15], v[12:13]
    v_cvt_pk_bf16_f32 v35, v14, v15
    v_cvt_pk_bf16_f32 v8, v168, v169
    v_cvt_pk_bf16_f32 v9, v216, v217
    v_lshlrev_b32 v10, 16, v8
    v_and_b32 v11, 0xffff0000, v8
    v_lshlrev_b32 v12, 16, v9
    v_and_b32 v13, 0xffff0000, v9
    v_pk_mul_f32 v[14:15], v[10:11], v[10:11]
    v_pk_fma_f32 v[14:15], v[14:15], s[72:73], 1.0 op_sel_hi:[1,1,0]
    v_pk_mul_f32 v[14:15], v[14:15], v[10:11]
    v_pk_mul_f32 v[14:15], v[14:15], s[70:71]
    v_exp_f32 v14, v14
    v_exp_f32 v15, v15
    s_nop 0
    v_pk_add_f32 v[14:15], v[14:15], 1.0 op_sel_hi:[1,0]
    v_rcp_f32 v14, v14
    v_rcp_f32 v15, v15
    s_nop 0
    v_pk_mul_f32 v[14:15], v[14:15], v[10:11]
    v_cvt_pk_bf16_f32 v8, v14, v15
    v_lshlrev_b32 v14, 16, v8
    v_and_b32 v15, 0xffff0000, v8
    v_pk_mul_f32 v[14:15], v[14:15], v[12:13]
    v_cvt_pk_bf16_f32 v36, v14, v15
    v_cvt_pk_bf16_f32 v8, v170, v171
    v_cvt_pk_bf16_f32 v9, v218, v219
    v_lshlrev_b32 v10, 16, v8
    v_and_b32 v11, 0xffff0000, v8
    v_lshlrev_b32 v12, 16, v9
    v_and_b32 v13, 0xffff0000, v9
    v_pk_mul_f32 v[14:15], v[10:11], v[10:11]
    v_pk_fma_f32 v[14:15], v[14:15], s[72:73], 1.0 op_sel_hi:[1,1,0]
    v_pk_mul_f32 v[14:15], v[14:15], v[10:11]
    v_pk_mul_f32 v[14:15], v[14:15], s[70:71]
    v_exp_f32 v14, v14
    v_exp_f32 v15, v15
    s_nop 0
    v_pk_add_f32 v[14:15], v[14:15], 1.0 op_sel_hi:[1,0]
    v_rcp_f32 v14, v14
    v_rcp_f32 v15, v15
    s_nop 0
    v_pk_mul_f32 v[14:15], v[14:15], v[10:11]
    v_cvt_pk_bf16_f32 v8, v14, v15
    v_lshlrev_b32 v14, 16, v8
    v_and_b32 v15, 0xffff0000, v8
    v_pk_mul_f32 v[14:15], v[14:15], v[12:13]
    v_cvt_pk_bf16_f32 v37, v14, v15
    v_cvt_pk_bf16_f32 v8, v172, v173
    v_cvt_pk_bf16_f32 v9, v220, v221
    v_lshlrev_b32 v10, 16, v8
    v_and_b32 v11, 0xffff0000, v8
    v_lshlrev_b32 v12, 16, v9
    v_and_b32 v13, 0xffff0000, v9
    v_pk_mul_f32 v[14:15], v[10:11], v[10:11]
    v_pk_fma_f32 v[14:15], v[14:15], s[72:73], 1.0 op_sel_hi:[1,1,0]
    v_pk_mul_f32 v[14:15], v[14:15], v[10:11]
    v_pk_mul_f32 v[14:15], v[14:15], s[70:71]
    v_exp_f32 v14, v14
    v_exp_f32 v15, v15
    s_nop 0
    v_pk_add_f32 v[14:15], v[14:15], 1.0 op_sel_hi:[1,0]
    v_rcp_f32 v14, v14
    v_rcp_f32 v15, v15
    s_nop 0
    v_pk_mul_f32 v[14:15], v[14:15], v[10:11]
    v_cvt_pk_bf16_f32 v8, v14, v15
    v_lshlrev_b32 v14, 16, v8
    v_and_b32 v15, 0xffff0000, v8
    v_pk_mul_f32 v[14:15], v[14:15], v[12:13]
    v_cvt_pk_bf16_f32 v38, v14, v15
    v_cvt_pk_bf16_f32 v8, v174, v175
    v_cvt_pk_bf16_f32 v9, v222, v223
    v_lshlrev_b32 v10, 16, v8
    v_and_b32 v11, 0xffff0000, v8
    v_lshlrev_b32 v12, 16, v9
    v_and_b32 v13, 0xffff0000, v9
    v_pk_mul_f32 v[14:15], v[10:11], v[10:11]
    v_pk_fma_f32 v[14:15], v[14:15], s[72:73], 1.0 op_sel_hi:[1,1,0]
    v_pk_mul_f32 v[14:15], v[14:15], v[10:11]
    v_pk_mul_f32 v[14:15], v[14:15], s[70:71]
    v_exp_f32 v14, v14
    v_exp_f32 v15, v15
    s_nop 0
    v_pk_add_f32 v[14:15], v[14:15], 1.0 op_sel_hi:[1,0]
    v_rcp_f32 v14, v14
    v_rcp_f32 v15, v15
    s_nop 0
    v_pk_mul_f32 v[14:15], v[14:15], v[10:11]
    v_cvt_pk_bf16_f32 v8, v14, v15
    v_lshlrev_b32 v14, 16, v8
    v_and_b32 v15, 0xffff0000, v8
    v_pk_mul_f32 v[14:15], v[14:15], v[12:13]
    v_cvt_pk_bf16_f32 v39, v14, v15
    buffer_store_dwordx4 v[32:35], v2, s[64:67], s50 offen offset:0
    buffer_store_dwordx4 v[36:39], v2, s[64:67], s50 offen offset:1024
    s_cmp_eq_u32 s48, 14
    s_cbranch_scc1 G1_DONE
    v_cvt_pk_bf16_f32 v8, v176, v177
    v_cvt_pk_bf16_f32 v9, v224, v225
    v_lshlrev_b32 v10, 16, v8
    v_and_b32 v11, 0xffff0000, v8
    v_lshlrev_b32 v12, 16, v9
    v_and_b32 v13, 0xffff0000, v9
    v_pk_mul_f32 v[14:15], v[10:11], v[10:11]
    v_pk_fma_f32 v[14:15], v[14:15], s[72:73], 1.0 op_sel_hi:[1,1,0]
    v_pk_mul_f32 v[14:15], v[14:15], v[10:11]
    v_pk_mul_f32 v[14:15], v[14:15], s[70:71]
    v_exp_f32 v14, v14
    v_exp_f32 v15, v15
    s_nop 0
    v_pk_add_f32 v[14:15], v[14:15], 1.0 op_sel_hi:[1,0]
    v_rcp_f32 v14, v14
    v_rcp_f32 v15, v15
    s_nop 0
    v_pk_mul_f32 v[14:15], v[14:15], v[10:11]
    v_cvt_pk_bf16_f32 v8, v14, v15
    v_lshlrev_b32 v14, 16, v8
    v_and_b32 v15, 0xffff0000, v8
    v_pk_mul_f32 v[14:15], v[14:15], v[12:13]
    v_cvt_pk_bf16_f32 v40, v14, v15
    v_cvt_pk_bf16_f32 v8, v178, v179
    v_cvt_pk_bf16_f32 v9, v226, v227
    v_lshlrev_b32 v10, 16, v8
    v_and_b32 v11, 0xffff0000, v8
    v_lshlrev_b32 v12, 16, v9
    v_and_b32 v13, 0xffff0000, v9
    v_pk_mul_f32 v[14:15], v[10:11], v[10:11]
    v_pk_fma_f32 v[14:15], v[14:15], s[72:73], 1.0 op_sel_hi:[1,1,0]
    v_pk_mul_f32 v[14:15], v[14:15], v[10:11]
    v_pk_mul_f32 v[14:15], v[14:15], s[70:71]
    v_exp_f32 v14, v14
    v_exp_f32 v15, v15
    s_nop 0
    v_pk_add_f32 v[14:15], v[14:15], 1.0 op_sel_hi:[1,0]
    v_rcp_f32 v14, v14
    v_rcp_f32 v15, v15
    s_nop 0
    v_pk_mul_f32 v[14:15], v[14:15], v[10:11]
    v_cvt_pk_bf16_f32 v8, v14, v15
    v_lshlrev_b32 v14, 16, v8
    v_and_b32 v15, 0xffff0000, v8
    v_pk_mul_f32 v[14:15], v[14:15], v[12:13]
    v_cvt_pk_bf16_f32 v41, v14, v15
    v_cvt_pk_bf16_f32 v8, v180, v181
    v_cvt_pk_bf16_f32 v9, v228, v229
    v_lshlrev_b32 v10, 16, v8
    v_and_b32 v11, 0xffff0000, v8
    v_lshlrev_b32 v12, 16, v9
    v_and_b32 v13, 0xffff0000, v9
    v_pk_mul_f32 v[14:15], v[10:11], v[10:11]
    v_pk_fma_f32 v[14:15], v[14:15], s[72:73], 1.0 op_sel_hi:[1,1,0]
    v_pk_mul_f32 v[14:15], v[14:15], v[10:11]
    v_pk_mul_f32 v[14:15], v[14:15], s[70:71]
    v_exp_f32 v14, v14
    v_exp_f32 v15, v15
    s_nop 0
    v_pk_add_f32 v[14:15], v[14:15], 1.0 op_sel_hi:[1,0]
    v_rcp_f32 v14, v14
    v_rcp_f32 v15, v15
    s_nop 0
    v_pk_mul_f32 v[14:15], v[14:15], v[10:11]
    v_cvt_pk_bf16_f32 v8, v14, v15
    v_lshlrev_b32 v14, 16, v8
    v_and_b32 v15, 0xffff0000, v8
    v_pk_mul_f32 v[14:15], v[14:15], v[12:13]
    v_cvt_pk_bf16_f32 v42, v14, v15
    v_cvt_pk_bf16_f32 v8, v182, v183
    v_cvt_pk_bf16_f32 v9, v230, v231
    v_lshlrev_b32 v10, 16, v8
    v_and_b32 v11, 0xffff0000, v8
    v_lshlrev_b32 v12, 16, v9
    v_and_b32 v13, 0xffff0000, v9
    v_pk_mul_f32 v[14:15], v[10:11], v[10:11]
    v_pk_fma_f32 v[14:15], v[14:15], s[72:73], 1.0 op_sel_hi:[1,1,0]
    v_pk_mul_f32 v[14:15], v[14:15], v[10:11]
    v_pk_mul_f32 v[14:15], v[14:15], s[70:71]
    v_exp_f32 v14, v14
    v_exp_f32 v15, v15
    s_nop 0
    v_pk_add_f32 v[14:15], v[14:15], 1.0 op_sel_hi:[1,0]
    v_rcp_f32 v14, v14
    v_rcp_f32 v15, v15
    s_nop 0
    v_pk_mul_f32 v[14:15], v[14:15], v[10:11]
    v_cvt_pk_bf16_f32 v8, v14, v15
    v_lshlrev_b32 v14, 16, v8
    v_and_b32 v15, 0xffff0000, v8
    v_pk_mul_f32 v[14:15], v[14:15], v[12:13]
    v_cvt_pk_bf16_f32 v43, v14, v15
    v_cvt_pk_bf16_f32 v8, v184, v185
    v_cvt_pk_bf16_f32 v9, v232, v233
    v_lshlrev_b32 v10, 16, v8
    v_and_b32 v11, 0xffff0000, v8
    v_lshlrev_b32 v12, 16, v9
    v_and_b32 v13, 0xffff0000, v9
    v_pk_mul_f32 v[14:15], v[10:11], v[10:11]
    v_pk_fma_f32 v[14:15], v[14:15], s[72:73], 1.0 op_sel_hi:[1,1,0]
    v_pk_mul_f32 v[14:15], v[14:15], v[10:11]
    v_pk_mul_f32 v[14:15], v[14:15], s[70:71]
    v_exp_f32 v14, v14
    v_exp_f32 v15, v15
    s_nop 0
    v_pk_add_f32 v[14:15], v[14:15], 1.0 op_sel_hi:[1,0]
    v_rcp_f32 v14, v14
    v_rcp_f32 v15, v15
    s_nop 0
    v_pk_mul_f32 v[14:15], v[14:15], v[10:11]
    v_cvt_pk_bf16_f32 v8, v14, v15
    v_lshlrev_b32 v14, 16, v8
    v_and_b32 v15, 0xffff0000, v8
    v_pk_mul_f32 v[14:15], v[14:15], v[12:13]
    v_cvt_pk_bf16_f32 v44, v14, v15
    v_cvt_pk_bf16_f32 v8, v186, v187
    v_cvt_pk_bf16_f32 v9, v234, v235
    v_lshlrev_b32 v10, 16, v8
    v_and_b32 v11, 0xffff0000, v8
    v_lshlrev_b32 v12, 16, v9
    v_and_b32 v13, 0xffff0000, v9
    v_pk_mul_f32 v[14:15], v[10:11], v[10:11]
    v_pk_fma_f32 v[14:15], v[14:15], s[72:73], 1.0 op_sel_hi:[1,1,0]
    v_pk_mul_f32 v[14:15], v[14:15], v[10:11]
    v_pk_mul_f32 v[14:15], v[14:15], s[70:71]
    v_exp_f32 v14, v14
    v_exp_f32 v15, v15
    s_nop 0
    v_pk_add_f32 v[14:15], v[14:15], 1.0 op_sel_hi:[1,0]
    v_rcp_f32 v14, v14
    v_rcp_f32 v15, v15
    s_nop 0
    v_pk_mul_f32 v[14:15], v[14:15], v[10:11]
    v_cvt_pk_bf16_f32 v8, v14, v15
    v_lshlrev_b32 v14, 16, v8
    v_and_b32 v15, 0xffff0000, v8
    v_pk_mul_f32 v[14:15], v[14:15], v[12:13]
    v_cvt_pk_bf16_f32 v45, v14, v15
    v_cvt_pk_bf16_f32 v8, v188, v189
    v_cvt_pk_bf16_f32 v9, v236, v237
    v_lshlrev_b32 v10, 16, v8
    v_and_b32 v11, 0xffff0000, v8
    v_lshlrev_b32 v12, 16, v9
    v_and_b32 v13, 0xffff0000, v9
    v_pk_mul_f32 v[14:15], v[10:11], v[10:11]
    v_pk_fma_f32 v[14:15], v[14:15], s[72:73], 1.0 op_sel_hi:[1,1,0]
    v_pk_mul_f32 v[14:15], v[14:15], v[10:11]
    v_pk_mul_f32 v[14:15], v[14:15], s[70:71]
    v_exp_f32 v14, v14
    v_exp_f32 v15, v15
    s_nop 0
    v_pk_add_f32 v[14:15], v[14:15], 1.0 op_sel_hi:[1,0]
    v_rcp_f32 v14, v14
    v_rcp_f32 v15, v15
    s_nop 0
    v_pk_mul_f32 v[14:15], v[14:15], v[10:11]
    v_cvt_pk_bf16_f32 v8, v14, v15
    v_lshlrev_b32 v14, 16, v8
    v_and_b32 v15, 0xffff0000, v8
    v_pk_mul_f32 v[14:15], v[14:15], v[12:13]
    v_cvt_pk_bf16_f32 v46, v14, v15
    v_cvt_pk_bf16_f32 v8, v190, v191
    v_cvt_pk_bf16_f32 v9, v238, v239
    v_lshlrev_b32 v10, 16, v8
    v_and_b32 v11, 0xffff0000, v8
    v_lshlrev_b32 v12, 16, v9
    v_and_b32 v13, 0xffff0000, v9
    v_pk_mul_f32 v[14:15], v[10:11], v[10:11]
    v_pk_fma_f32 v[14:15], v[14:15], s[72:73], 1.0 op_sel_hi:[1,1,0]
    v_pk_mul_f32 v[14:15], v[14:15], v[10:11]
    v_pk_mul_f32 v[14:15], v[14:15], s[70:71]
    v_exp_f32 v14, v14
    v_exp_f32 v15, v15
    s_nop 0
    v_pk_add_f32 v[14:15], v[14:15], 1.0 op_sel_hi:[1,0]
    v_rcp_f32 v14, v14
    v_rcp_f32 v15, v15
    s_nop 0
    v_pk_mul_f32 v[14:15], v[14:15], v[10:11]
    v_cvt_pk_bf16_f32 v8, v14, v15
    v_lshlrev_b32 v14, 16, v8
    v_and_b32 v15, 0xffff0000, v8
    v_pk_mul_f32 v[14:15], v[14:15], v[12:13]
    v_cvt_pk_bf16_f32 v47, v14, v15
    buffer_store_dwordx4 v[40:43], v2, s[64:67], s50 offen offset:2048
    buffer_store_dwordx4 v[44:47], v2, s[64:67], s50 offen offset:3072
    v_cvt_pk_bf16_f32 v8, v192, v193
    v_cvt_pk_bf16_f32 v9, v240, v241
    v_lshlrev_b32 v10, 16, v8
    v_and_b32 v11, 0xffff0000, v8
    v_lshlrev_b32 v12, 16, v9
    v_and_b32 v13, 0xffff0000, v9
    v_pk_mul_f32 v[14:15], v[10:11], v[10:11]
    v_pk_fma_f32 v[14:15], v[14:15], s[72:73], 1.0 op_sel_hi:[1,1,0]
    v_pk_mul_f32 v[14:15], v[14:15], v[10:11]
    v_pk_mul_f32 v[14:15], v[14:15], s[70:71]
    v_exp_f32 v14, v14
    v_exp_f32 v15, v15
    s_nop 0
    v_pk_add_f32 v[14:15], v[14:15], 1.0 op_sel_hi:[1,0]
    v_rcp_f32 v14, v14
    v_rcp_f32 v15, v15
    s_nop 0
    v_pk_mul_f32 v[14:15], v[14:15], v[10:11]
    v_cvt_pk_bf16_f32 v8, v14, v15
    v_lshlrev_b32 v14, 16, v8
    v_and_b32 v15, 0xffff0000, v8
    v_pk_mul_f32 v[14:15], v[14:15], v[12:13]
    v_cvt_pk_bf16_f32 v48, v14, v15
    v_cvt_pk_bf16_f32 v8, v194, v195
    v_cvt_pk_bf16_f32 v9, v242, v243
    v_lshlrev_b32 v10, 16, v8
    v_and_b32 v11, 0xffff0000, v8
    v_lshlrev_b32 v12, 16, v9
    v_and_b32 v13, 0xffff0000, v9
    v_pk_mul_f32 v[14:15], v[10:11], v[10:11]
    v_pk_fma_f32 v[14:15], v[14:15], s[72:73], 1.0 op_sel_hi:[1,1,0]
    v_pk_mul_f32 v[14:15], v[14:15], v[10:11]
    v_pk_mul_f32 v[14:15], v[14:15], s[70:71]
    v_exp_f32 v14, v14
    v_exp_f32 v15, v15
    s_nop 0
    v_pk_add_f32 v[14:15], v[14:15], 1.0 op_sel_hi:[1,0]
    v_rcp_f32 v14, v14
    v_rcp_f32 v15, v15
    s_nop 0
    v_pk_mul_f32 v[14:15], v[14:15], v[10:11]
    v_cvt_pk_bf16_f32 v8, v14, v15
    v_lshlrev_b32 v14, 16, v8
    v_and_b32 v15, 0xffff0000, v8
    v_pk_mul_f32 v[14:15], v[14:15], v[12:13]
    v_cvt_pk_bf16_f32 v49, v14, v15
    v_cvt_pk_bf16_f32 v8, v196, v197
    v_cvt_pk_bf16_f32 v9, v244, v245
    v_lshlrev_b32 v10, 16, v8
    v_and_b32 v11, 0xffff0000, v8
    v_lshlrev_b32 v12, 16, v9
    v_and_b32 v13, 0xffff0000, v9
    v_pk_mul_f32 v[14:15], v[10:11], v[10:11]
    v_pk_fma_f32 v[14:15], v[14:15], s[72:73], 1.0 op_sel_hi:[1,1,0]
    v_pk_mul_f32 v[14:15], v[14:15], v[10:11]
    v_pk_mul_f32 v[14:15], v[14:15], s[70:71]
    v_exp_f32 v14, v14
    v_exp_f32 v15, v15
    s_nop 0
    v_pk_add_f32 v[14:15], v[14:15], 1.0 op_sel_hi:[1,0]
    v_rcp_f32 v14, v14
    v_rcp_f32 v15, v15
    s_nop 0
    v_pk_mul_f32 v[14:15], v[14:15], v[10:11]
    v_cvt_pk_bf16_f32 v8, v14, v15
    v_lshlrev_b32 v14, 16, v8
    v_and_b32 v15, 0xffff0000, v8
    v_pk_mul_f32 v[14:15], v[14:15], v[12:13]
    v_cvt_pk_bf16_f32 v50, v14, v15
    v_cvt_pk_bf16_f32 v8, v198, v199
    v_cvt_pk_bf16_f32 v9, v246, v247
    v_lshlrev_b32 v10, 16, v8
    v_and_b32 v11, 0xffff0000, v8
    v_lshlrev_b32 v12, 16, v9
    v_and_b32 v13, 0xffff0000, v9
    v_pk_mul_f32 v[14:15], v[10:11], v[10:11]
    v_pk_fma_f32 v[14:15], v[14:15], s[72:73], 1.0 op_sel_hi:[1,1,0]
    v_pk_mul_f32 v[14:15], v[14:15], v[10:11]
    v_pk_mul_f32 v[14:15], v[14:15], s[70:71]
    v_exp_f32 v14, v14
    v_exp_f32 v15, v15
    s_nop 0
    v_pk_add_f32 v[14:15], v[14:15], 1.0 op_sel_hi:[1,0]
    v_rcp_f32 v14, v14
    v_rcp_f32 v15, v15
    s_nop 0
    v_pk_mul_f32 v[14:15], v[14:15], v[10:11]
    v_cvt_pk_bf16_f32 v8, v14, v15
    v_lshlrev_b32 v14, 16, v8
    v_and_b32 v15, 0xffff0000, v8
    v_pk_mul_f32 v[14:15], v[14:15], v[12:13]
    v_cvt_pk_bf16_f32 v51, v14, v15
    v_cvt_pk_bf16_f32 v8, v200, v201
    v_cvt_pk_bf16_f32 v9, v248, v249
    v_lshlrev_b32 v10, 16, v8
    v_and_b32 v11, 0xffff0000, v8
    v_lshlrev_b32 v12, 16, v9
    v_and_b32 v13, 0xffff0000, v9
    v_pk_mul_f32 v[14:15], v[10:11], v[10:11]
    v_pk_fma_f32 v[14:15], v[14:15], s[72:73], 1.0 op_sel_hi:[1,1,0]
    v_pk_mul_f32 v[14:15], v[14:15], v[10:11]
    v_pk_mul_f32 v[14:15], v[14:15], s[70:71]
    v_exp_f32 v14, v14
    v_exp_f32 v15, v15
    s_nop 0
    v_pk_add_f32 v[14:15], v[14:15], 1.0 op_sel_hi:[1,0]
    v_rcp_f32 v14, v14
    v_rcp_f32 v15, v15
    s_nop 0
    v_pk_mul_f32 v[14:15], v[14:15], v[10:11]
    v_cvt_pk_bf16_f32 v8, v14, v15
    v_lshlrev_b32 v14, 16, v8
    v_and_b32 v15, 0xffff0000, v8
    v_pk_mul_f32 v[14:15], v[14:15], v[12:13]
    v_cvt_pk_bf16_f32 v52, v14, v15
    v_cvt_pk_bf16_f32 v8, v202, v203
    v_cvt_pk_bf16_f32 v9, v250, v251
    v_lshlrev_b32 v10, 16, v8
    v_and_b32 v11, 0xffff0000, v8
    v_lshlrev_b32 v12, 16, v9
    v_and_b32 v13, 0xffff0000, v9
    v_pk_mul_f32 v[14:15], v[10:11], v[10:11]
    v_pk_fma_f32 v[14:15], v[14:15], s[72:73], 1.0 op_sel_hi:[1,1,0]
    v_pk_mul_f32 v[14:15], v[14:15], v[10:11]
    v_pk_mul_f32 v[14:15], v[14:15], s[70:71]
    v_exp_f32 v14, v14
    v_exp_f32 v15, v15
    s_nop 0
    v_pk_add_f32 v[14:15], v[14:15], 1.0 op_sel_hi:[1,0]
    v_rcp_f32 v14, v14
    v_rcp_f32 v15, v15
    s_nop 0
    v_pk_mul_f32 v[14:15], v[14:15], v[10:11]
    v_cvt_pk_bf16_f32 v8, v14, v15
    v_lshlrev_b32 v14, 16, v8
    v_and_b32 v15, 0xffff0000, v8
    v_pk_mul_f32 v[14:15], v[14:15], v[12:13]
    v_cvt_pk_bf16_f32 v53, v14, v15
    v_cvt_pk_bf16_f32 v8, v204, v205
    v_cvt_pk_bf16_f32 v9, v252, v253
    v_lshlrev_b32 v10, 16, v8
    v_and_b32 v11, 0xffff0000, v8
    v_lshlrev_b32 v12, 16, v9
    v_and_b32 v13, 0xffff0000, v9
    v_pk_mul_f32 v[14:15], v[10:11], v[10:11]
    v_pk_fma_f32 v[14:15], v[14:15], s[72:73], 1.0 op_sel_hi:[1,1,0]
    v_pk_mul_f32 v[14:15], v[14:15], v[10:11]
    v_pk_mul_f32 v[14:15], v[14:15], s[70:71]
    v_exp_f32 v14, v14
    v_exp_f32 v15, v15
    s_nop 0
    v_pk_add_f32 v[14:15], v[14:15], 1.0 op_sel_hi:[1,0]
    v_rcp_f32 v14, v14
    v_rcp_f32 v15, v15
    s_nop 0
    v_pk_mul_f32 v[14:15], v[14:15], v[10:11]
    v_cvt_pk_bf16_f32 v8, v14, v15
    v_lshlrev_b32 v14, 16, v8
    v_and_b32 v15, 0xffff0000, v8
    v_pk_mul_f32 v[14:15], v[14:15], v[12:13]
    v_cvt_pk_bf16_f32 v54, v14, v15
    v_cvt_pk_bf16_f32 v8, v206, v207
    v_cvt_pk_bf16_f32 v9, v254, v255
    v_lshlrev_b32 v10, 16, v8
    v_and_b32 v11, 0xffff0000, v8
    v_lshlrev_b32 v12, 16, v9
    v_and_b32 v13, 0xffff0000, v9
    v_pk_mul_f32 v[14:15], v[10:11], v[10:11]
    v_pk_fma_f32 v[14:15], v[14:15], s[72:73], 1.0 op_sel_hi:[1,1,0]
    v_pk_mul_f32 v[14:15], v[14:15], v[10:11]
    v_pk_mul_f32 v[14:15], v[14:15], s[70:71]
    v_exp_f32 v14, v14
    v_exp_f32 v15, v15
    s_nop 0
    v_pk_add_f32 v[14:15], v[14:15], 1.0 op_sel_hi:[1,0]
    v_rcp_f32 v14, v14
    v_rcp_f32 v15, v15
    s_nop 0
    v_pk_mul_f32 v[14:15], v[14:15], v[10:11]
    v_cvt_pk_bf16_f32 v8, v14, v15
    v_lshlrev_b32 v14, 16, v8
    v_and_b32 v15, 0xffff0000, v8
    v_pk_mul_f32 v[14:15], v[14:15], v[12:13]
    v_cvt_pk_bf16_f32 v55, v14, v15
    s_add_u32 s50, s50, 4096
    buffer_store_dwordx4 v[48:51], v2, s[64:67], s50 offen offset:0
    buffer_store_dwordx4 v[52:55], v2, s[64:67], s50 offen offset:1024
G1_DONE:
    s_endpgm
AUX:
    s_sub_u32 s46, s2, 256
    s_and_b32 s47, s46, 1
    s_lshl_b32 s47, s47, 3
    s_bfe_u32 s46, s46, 0x30003
    s_add_u32 s46, s46, s47
    s_lshl_b32 s46, s46, 2
    s_add_u32 s46, s46, s49
    s_mov_b32 s52, s36
    s_mov_b32 s53, s37
    s_and_b32 s53, s53, 0xffff
    s_mov_b32 s54, 1409024
    s_mov_b32 s55, 0x00020000
    s_add_u32 s56, s44, 6291456
    s_addc_u32 s57, s45, 0
    s_and_b32 s57, s57, 0xffff
    s_mov_b32 s58, 1409024
    s_mov_b32 s59, 0x00020000
    s_mov_b32 s60, s16
    s_mov_b32 s61, s17
    s_and_b32 s61, s61, 0xffff
    s_mov_b32 s62, 2097152
    s_mov_b32 s63, 0x00020000
    s_mov_b32 s64, s38
    s_mov_b32 s65, s39
    s_and_b32 s65, s65, 0xffff
    s_mov_b32 s66, 1024
    s_mov_b32 s67, 0x00020000
    s_add_u32 s68, s44, 10485760
    s_addc_u32 s69, s45, 0
    s_and_b32 s69, s69, 0xffff
    s_mov_b32 s70, 8192
    s_mov_b32 s71, 0x00020000
    v_lshlrev_b32 v3, 4, v1
    v_lshrrev_b32 v2, 5, v1
    v_lshlrev_b32 v2, 10, v2
    v_and_b32 v4, 31, v1
    v_lshlrev_b32 v4, 4, v4
    v_add_u32 v2, v2, v4
    s_lshl_b32 s51, s49, 14
    v_and_b32 v8, 15, v1
    v_lshrrev_b32 v9, 5, v1
    v_lshlrev_b32 v9, 2, v9
    v_lshrrev_b32 v10, 2, v8
    v_add_u32 v9, v9, v10
    v_lshlrev_b32 v9, 9, v9
    v_lshrrev_b32 v10, 4, v1
    v_and_b32 v10, 1, v10
    v_lshlrev_b32 v10, 5, v10
    v_and_b32 v11, 3, v8
    v_lshlrev_b32 v11, 3, v11
    v_add3_u32 v4, v9, v10, v11
    v_add_u32 v4, s51, v4
    s_mov_b32 s47, s46
AUX_WD:
    s_lshr_b32 s48, s47, 1
    s_and_b32 s50, s47, 1
    s_lshl_b32 s72, s48, 15
    s_lshl_b32 s73, s50, 9
    s_add_u32 s72, s72, s73
    s_add_u32 s73, s72, 0
    s_add_u32 s74, s51, 0
    s_mov_b32 m0, s74
    s_nop 0
    buffer_load_dwordx4 v2, s[52:55], s73 offen lds
    s_add_u32 s73, s72, 2048
    s_add_u32 s74, s51, 1024
    s_mov_b32 m0, s74
    s_nop 0
    buffer_load_dwordx4 v2, s[52:55], s73 offen lds
    s_add_u32 s73, s72, 4096
    s_add_u32 s74, s51, 2048
    s_mov_b32 m0, s74
    s_nop 0
    buffer_load_dwordx4 v2, s[52:55], s73 offen lds
    s_add_u32 s73, s72, 6144
    s_add_u32 s74, s51, 3072
    s_mov_b32 m0, s74
    s_nop 0
    buffer_load_dwordx4 v2, s[52:55], s73 offen lds
    s_add_u32 s73, s72, 8192
    s_add_u32 s74, s51, 4096
    s_mov_b32 m0, s74
    s_nop 0
    buffer_load_dwordx4 v2, s[52:55], s73 offen lds
    s_add_u32 s73, s72, 10240
    s_add_u32 s74, s51, 5120
    s_mov_b32 m0, s74
    s_nop 0
    buffer_load_dwordx4 v2, s[52:55], s73 offen lds
    s_add_u32 s73, s72, 12288
    s_add_u32 s74, s51, 6144
    s_mov_b32 m0, s74
    s_nop 0
    buffer_load_dwordx4 v2, s[52:55], s73 offen lds
    s_add_u32 s73, s72, 14336
    s_add_u32 s74, s51, 7168
    s_mov_b32 m0, s74
    s_nop 0
    buffer_load_dwordx4 v2, s[52:55], s73 offen lds
    s_add_u32 s73, s72, 16384
    s_add_u32 s74, s51, 8192
    s_mov_b32 m0, s74
    s_nop 0
    buffer_load_dwordx4 v2, s[52:55], s73 offen lds
    s_add_u32 s73, s72, 18432
    s_add_u32 s74, s51, 9216
    s_mov_b32 m0, s74
    s_nop 0
    buffer_load_dwordx4 v2, s[52:55], s73 offen lds
    s_add_u32 s73, s72, 20480
    s_add_u32 s74, s51, 10240
    s_mov_b32 m0, s74
    s_nop 0
    buffer_load_dwordx4 v2, s[52:55], s73 offen lds
    s_add_u32 s73, s72, 22528
    s_add_u32 s74, s51, 11264
    s_mov_b32 m0, s74
    s_nop 0
    buffer_load_dwordx4 v2, s[52:55], s73 offen lds
    s_add_u32 s73, s72, 24576
    s_add_u32 s74, s51, 12288
    s_mov_b32 m0, s74
    s_nop 0
    buffer_load_dwordx4 v2, s[52:55], s73 offen lds
    s_add_u32 s73, s72, 26624
    s_add_u32 s74, s51, 13312
    s_mov_b32 m0, s74
    s_nop 0
    buffer_load_dwordx4 v2, s[52:55], s73 offen lds
    s_add_u32 s73, s72, 28672
    s_add_u32 s74, s51, 14336
    s_mov_b32 m0, s74
    s_nop 0
    buffer_load_dwordx4 v2, s[52:55], s73 offen lds
    s_add_u32 s73, s72, 30720
    s_add_u32 s74, s51, 15360
    s_mov_b32 m0, s74
    s_nop 0
    buffer_load_dwordx4 v2, s[52:55], s73 offen lds
    s_lshl_b32 s73, s50, 3
    s_mul_i32 s73, s73, 43
    s_add_u32 s73, s73, s48
    s_lshl_b32 s73, s73, 11
    s_waitcnt vmcnt(0)
    ds_read_b64_tr_b16 v[20:21], v4 offset:0
    ds_read_b64_tr_b16 v[22:23], v4 offset:4096
    ds_read_b64_tr_b16 v[24:25], v4 offset:8192
    ds_read_b64_tr_b16 v[26:27], v4 offset:12288
    ds_read_b64_tr_b16 v[28:29], v4 offset:64
    ds_read_b64_tr_b16 v[30:31], v4 offset:4160
    ds_read_b64_tr_b16 v[32:33], v4 offset:8256
    ds_read_b64_tr_b16 v[34:35], v4 offset:12352
    ds_read_b64_tr_b16 v[36:37], v4 offset:128
    ds_read_b64_tr_b16 v[38:39], v4 offset:4224
    ds_read_b64_tr_b16 v[40:41], v4 offset:8320
    ds_read_b64_tr_b16 v[42:43], v4 offset:12416
    ds_read_b64_tr_b16 v[44:45], v4 offset:192
    ds_read_b64_tr_b16 v[46:47], v4 offset:4288
    ds_read_b64_tr_b16 v[48:49], v4 offset:8384
    ds_read_b64_tr_b16 v[50:51], v4 offset:12480
    s_waitcnt lgkmcnt(0)
    s_add_u32 s74, s73, 0
    buffer_store_dwordx4 v[20:23], v3, s[56:59], s74 offen offset:0
    buffer_store_dwordx4 v[24:27], v3, s[56:59], s74 offen offset:1024
    s_add_u32 s74, s73, 88064
    buffer_store_dwordx4 v[28:31], v3, s[56:59], s74 offen offset:0
    buffer_store_dwordx4 v[32:35], v3, s[56:59], s74 offen offset:1024
    s_add_u32 s74, s73, 176128
    buffer_store_dwordx4 v[36:39], v3, s[56:59], s74 offen offset:0
    buffer_store_dwordx4 v[40:43], v3, s[56:59], s74 offen offset:1024
    s_add_u32 s74, s73, 264192
    buffer_store_dwordx4 v[44:47], v3, s[56:59], s74 offen offset:0
    buffer_store_dwordx4 v[48:51], v3, s[56:59], s74 offen offset:1024
    s_nop 1
    ds_read_b64_tr_b16 v[20:21], v4 offset:256
    ds_read_b64_tr_b16 v[22:23], v4 offset:4352
    ds_read_b64_tr_b16 v[24:25], v4 offset:8448
    ds_read_b64_tr_b16 v[26:27], v4 offset:12544
    ds_read_b64_tr_b16 v[28:29], v4 offset:320
    ds_read_b64_tr_b16 v[30:31], v4 offset:4416
    ds_read_b64_tr_b16 v[32:33], v4 offset:8512
    ds_read_b64_tr_b16 v[34:35], v4 offset:12608
    ds_read_b64_tr_b16 v[36:37], v4 offset:384
    ds_read_b64_tr_b16 v[38:39], v4 offset:4480
    ds_read_b64_tr_b16 v[40:41], v4 offset:8576
    ds_read_b64_tr_b16 v[42:43], v4 offset:12672
    ds_read_b64_tr_b16 v[44:45], v4 offset:448
    ds_read_b64_tr_b16 v[46:47], v4 offset:4544
    ds_read_b64_tr_b16 v[48:49], v4 offset:8640
    ds_read_b64_tr_b16 v[50:51], v4 offset:12736
    s_waitcnt lgkmcnt(0)
    s_add_u32 s74, s73, 352256
    buffer_store_dwordx4 v[20:23], v3, s[56:59], s74 offen offset:0
    buffer_store_dwordx4 v[24:27], v3, s[56:59], s74 offen offset:1024
    s_add_u32 s74, s73, 440320
    buffer_store_dwordx4 v[28:31], v3, s[56:59], s74 offen offset:0
    buffer_store_dwordx4 v[32:35], v3, s[56:59], s74 offen offset:1024
    s_add_u32 s74, s73, 528384
    buffer_store_dwordx4 v[36:39], v3, s[56:59], s74 offen offset:0
    buffer_store_dwordx4 v[40:43], v3, s[56:59], s74 offen offset:1024
    s_add_u32 s74, s73, 616448
    buffer_store_dwordx4 v[44:47], v3, s[56:59], s74 offen offset:0
    buffer_store_dwordx4 v[48:51], v3, s[56:59], s74 offen offset:1024
    s_nop 1
    s_add_u32 s47, s47, 64
    s_cmp_lt_u32 s47, 86
    s_cbranch_scc1 AUX_WD
    s_endpgm
    .globl k2_kernel
    .type k2_kernel,@function
    .p2align 8
k2_kernel:
    s_cmp_ge_u32 s2, 256
    s_cbranch_scc1 K2_EXIT
    s_load_dwordx16 s[16:31], s[0:1], 0
    s_load_dwordx8 s[32:39], s[0:1], 64
    s_load_dwordx4 s[40:43], s[0:1], 96
    s_load_dwordx2 s[44:45], s[0:1], 112
    v_and_b32 v1, 63, v0
    v_lshrrev_b32 v2, 6, v0
    s_nop 0
    v_readfirstlane_b32 s49, v2
    s_waitcnt lgkmcnt(0)
    s_lshr_b32 s46, s2, 5
    s_and_b32 s47, s2, 7
    s_lshl_b32 s47, s47, 2
    s_bfe_u32 s48, s2, 0x20003
    s_add_u32 s47, s47, s48
    s_mov_b32 s52, s44
    s_mov_b32 s53, s45
    s_and_b32 s53, s53, 0xffff
    s_mov_b32 s54, 5636096
    s_mov_b32 s55, 0x00020000
    s_add_u32 s56, s44, 6291456
    s_addc_u32 s57, s45, 0
    s_and_b32 s57, s57, 0xffff
    s_mov_b32 s58, 1409024
    s_mov_b32 s59, 0x00020000
    s_add_u32 s60, s44, 8388608
    s_addc_u32 s61, s45, 0
    s_and_b32 s61, s61, 0xffff
    s_mov_b32 s62, 2097152
    s_mov_b32 s63, 0x00020000
    s_add_u32 s64, s44, 10485760
    s_addc_u32 s65, s45, 0
    s_and_b32 s65, s65, 0xffff
    s_mov_b32 s66, 8192
    s_mov_b32 s67, 0x00020000
    s_mov_b32 s68, s40
    s_mov_b32 s69, s41
    s_and_b32 s69, s69, 0xffff
    s_mov_b32 s70, 2097152
    s_mov_b32 s71, 0x00020000
    v_lshlrev_b32 v2, 4, v1
    s_mul_i32 s72, s46, 176128
    s_add_u32 s73, s72, 88064
    s_mul_i32 s74, s47, 176128
    s_add_u32 s75, s74, 88064
    s_add_u32 s76, s49, 0
    s_min_u32 s76, s76, 42
    s_lshl_b32 s76, s76, 11
    s_add_u32 s77, s76, s72
    buffer_load_dwordx4 v[32:35], v2, s[56:59], s77 offen offset:0
    buffer_load_dwordx4 v[36:39], v2, s[56:59], s77 offen offset:1024
    s_add_u32 s77, s76, s73
    buffer_load_dwordx4 v[40:43], v2, s[56:59], s77 offen offset:0
    buffer_load_dwordx4 v[44:47], v2, s[56:59], s77 offen offset:1024
    s_add_u32 s77, s76, s74
    buffer_load_dwordx4 v[48:51], v2, s[52:55], s77 offen offset:0
    buffer_load_dwordx4 v[52:55], v2, s[52:55], s77 offen offset:1024
    s_add_u32 s77, s76, s75
    buffer_load_dwordx4 v[56:59], v2, s[52:55], s77 offen offset:0
    buffer_load_dwordx4 v[60:63], v2, s[52:55], s77 offen offset:1024
    s_add_u32 s76, s49, 4
    s_min_u32 s76, s76, 42
    s_lshl_b32 s76, s76, 11
    s_add_u32 s77, s76, s72
    buffer_load_dwordx4 v[64:67], v2, s[56:59], s77 offen offset:0
    buffer_load_dwordx4 v[68:71], v2, s[56:59], s77 offen offset:1024
    s_add_u32 s77, s76, s73
    buffer_load_dwordx4 v[72:75], v2, s[56:59], s77 offen offset:0
    buffer_load_dwordx4 v[76:79], v2, s[56:59], s77 offen offset:1024
    s_add_u32 s77, s76, s74
    buffer_load_dwordx4 v[80:83], v2, s[52:55], s77 offen offset:0
    buffer_load_dwordx4 v[84:87], v2, s[52:55], s77 offen offset:1024
    s_add_u32 s77, s76, s75
    buffer_load_dwordx4 v[88:91], v2, s[52:55], s77 offen offset:0
    buffer_load_dwordx4 v[92:95], v2, s[52:55], s77 offen offset:1024
    s_add_u32 s76, s49, 8
    s_min_u32 s76, s76, 42
    s_lshl_b32 s76, s76, 11
    s_add_u32 s77, s76, s72
    buffer_load_dwordx4 v[96:99], v2, s[56:59], s77 offen offset:0
    buffer_load_dwordx4 v[100:103], v2, s[56:59], s77 offen offset:1024
    s_add_u32 s77, s76, s73
    buffer_load_dwordx4 v[104:107], v2, s[56:59], s77 offen offset:0
    buffer_load_dwordx4 v[108:111], v2, s[56:59], s77 offen offset:1024
    s_add_u32 s77, s76, s74
    buffer_load_dwordx4 v[112:115], v2, s[52:55], s77 offen offset:0
    buffer_load_dwordx4 v[116:119], v2, s[52:55], s77 offen offset:1024
    s_add_u32 s77, s76, s75
    buffer_load_dwordx4 v[120:123], v2, s[52:55], s77 offen offset:0
    buffer_load_dwordx4 v[124:127], v2, s[52:55], s77 offen offset:1024
    s_add_u32 s76, s49, 12
    s_min_u32 s76, s76, 42
    s_lshl_b32 s76, s76, 11
    s_add_u32 s77, s76, s72
    buffer_load_dwordx4 v[128:131], v2, s[56:59], s77 offen offset:0
    buffer_load_dwordx4 v[132:135], v2, s[56:59], s77 offen offset:1024
    s_add_u32 s77, s76, s73
    buffer_load_dwordx4 v[136:139], v2, s[56:59], s77 offen offset:0
    buffer_load_dwordx4 v[140:143], v2, s[56:59], s77 offen offset:1024
    s_add_u32 s77, s76, s74
    buffer_load_dwordx4 v[144:147], v2, s[52:55], s77 offen offset:0
    buffer_load_dwordx4 v[148:151], v2, s[52:55], s77 offen offset:1024
    s_add_u32 s77, s76, s75
    buffer_load_dwordx4 v[152:155], v2, s[52:55], s77 offen offset:0
    buffer_load_dwordx4 v[156:159], v2, s[52:55], s77 offen offset:1024
    s_and_b32 s76, s49, 1
    s_lshr_b32 s77, s49, 1
    s_lshl_b32 s78, s47, 6
    s_lshl_b32 s79, s77, 5
    s_add_u32 s78, s78, s79
    v_and_b32 v4, 31, v1
    v_add_u32 v4, s78, v4
    v_lshlrev_b32 v5, 2, v4
    v_lshlrev_b32 v3, 1, v4
    v_lshlrev_b32 v4, 10, v4
    s_lshl_b32 s78, s46, 6
    s_lshl_b32 s79, s76, 5
    s_add_u32 s78, s78, s79
    v_lshrrev_b32 v6, 5, v1
    v_lshlrev_b32 v7, 3, v6
    v_add_u32 v4, v4, v7
    s_lshl_b32 s79, s78, 1
    v_add_u32 v4, s79, v4
    v_lshlrev_b32 v6, 14, v6
    v_add_u32 v3, v3, v6
    s_lshl_b32 s78, s78, 12
    buffer_load_dword v7, v5, s[64:67], 0 offen
    s_add_u32 s79, s78, 0
    buffer_load_ushort v8, v3, s[60:63], s79 offen
    s_add_u32 s79, s78, 4096
    buffer_load_ushort v9, v3, s[60:63], s79 offen
    s_add_u32 s79, s78, 8192
    buffer_load_ushort v10, v3, s[60:63], s79 offen
    s_add_u32 s79, s78, 12288
    buffer_load_ushort v11, v3, s[60:63], s79 offen
    s_add_u32 s79, s78, 32768
    buffer_load_ushort v12, v3, s[60:63], s79 offen
    s_add_u32 s79, s78, 36864
    buffer_load_ushort v13, v3, s[60:63], s79 offen
    s_add_u32 s79, s78, 40960
    buffer_load_ushort v14, v3, s[60:63], s79 offen
    s_add_u32 s79, s78, 45056
    buffer_load_ushort v15, v3, s[60:63], s79 offen
    s_add_u32 s79, s78, 65536
    buffer_load_ushort v16, v3, s[60:63], s79 offen
    s_add_u32 s79, s78, 69632
    buffer_load_ushort v17, v3, s[60:63], s79 offen
    s_add_u32 s79, s78, 73728
    buffer_load_ushort v18, v3, s[60:63], s79 offen
    s_add_u32 s79, s78, 77824
    buffer_load_ushort v19, v3, s[60:63], s79 offen
    s_add_u32 s79, s78, 98304
    buffer_load_ushort v20, v3, s[60:63], s79 offen
    s_add_u32 s79, s78, 102400
    buffer_load_ushort v21, v3, s[60:63], s79 offen
    s_add_u32 s79, s78, 106496
    buffer_load_ushort v22, v3, s[60:63], s79 offen
    s_add_u32 s79, s78, 110592
    buffer_load_ushort v23, v3, s[60:63], s79 offen
    v_mov_b32 v192, 0
    v_mov_b32 v193, 0
    v_mov_b32 v194, 0
    v_mov_b32 v195, 0
    v_mov_b32 v196, 0
    v_mov_b32 v197, 0
    v_mov_b32 v198, 0
    v_mov_b32 v199, 0
    v_mov_b32 v200, 0
    v_mov_b32 v201, 0
    v_mov_b32 v202, 0
    v_mov_b32 v203, 0
    v_mov_b32 v204, 0
    v_mov_b32 v205, 0
    v_mov_b32 v206, 0
    v_mov_b32 v207, 0
    v_mov_b32 v208, 0
    v_mov_b32 v209, 0
    v_mov_b32 v210, 0
    v_mov_b32 v211, 0
    v_mov_b32 v212, 0
    v_mov_b32 v213, 0
    v_mov_b32 v214, 0
    v_mov_b32 v215, 0
    v_mov_b32 v216, 0
    v_mov_b32 v217, 0
    v_mov_b32 v218, 0
    v_mov_b32 v219, 0
    v_mov_b32 v220, 0
    v_mov_b32 v221, 0
    v_mov_b32 v222, 0
    v_mov_b32 v223, 0
    v_mov_b32 v224, 0
    v_mov_b32 v225, 0
    v_mov_b32 v226, 0
    v_mov_b32 v227, 0
    v_mov_b32 v228, 0
    v_mov_b32 v229, 0
    v_mov_b32 v230, 0
    v_mov_b32 v231, 0
    v_mov_b32 v232, 0
    v_mov_b32 v233, 0
    v_mov_b32 v234, 0
    v_mov_b32 v235, 0
    v_mov_b32 v236, 0
    v_mov_b32 v237, 0
    v_mov_b32 v238, 0
    v_mov_b32 v239, 0
    v_mov_b32 v240, 0
    v_mov_b32 v241, 0
    v_mov_b32 v242, 0
    v_mov_b32 v243, 0
    v_mov_b32 v244, 0
    v_mov_b32 v245, 0
    v_mov_b32 v246, 0
    v_mov_b32 v247, 0
    v_mov_b32 v248, 0
    v_mov_b32 v249, 0
    v_mov_b32 v250, 0
    v_mov_b32 v251, 0
    v_mov_b32 v252, 0
    v_mov_b32 v253, 0
    v_mov_b32 v254, 0
    v_mov_b32 v255, 0
    s_waitcnt vmcnt(41)
    v_mfma_f32_32x32x16_bf16 v[192:207], v[32:35], v[48:51], v[192:207]
    v_mfma_f32_32x32x16_bf16 v[208:223], v[40:43], v[48:51], v[208:223]
    v_mfma_f32_32x32x16_bf16 v[224:239], v[32:35], v[56:59], v[224:239]
    v_mfma_f32_32x32x16_bf16 v[240:255], v[40:43], v[56:59], v[240:255]
    v_mfma_f32_32x32x16_bf16 v[192:207], v[36:39], v[52:55], v[192:207]
    v_mfma_f32_32x32x16_bf16 v[208:223], v[44:47], v[52:55], v[208:223]
    v_mfma_f32_32x32x16_bf16 v[224:239], v[36:39], v[60:63], v[224:239]
    v_mfma_f32_32x32x16_bf16 v[240:255], v[44:47], v[60:63], v[240:255]
    s_add_u32 s76, s49, 16
    s_min_u32 s76, s76, 42
    s_lshl_b32 s76, s76, 11
    s_add_u32 s77, s76, s72
    buffer_load_dwordx4 v[32:35], v2, s[56:59], s77 offen offset:0
    buffer_load_dwordx4 v[36:39], v2, s[56:59], s77 offen offset:1024
    s_add_u32 s77, s76, s73
    buffer_load_dwordx4 v[40:43], v2, s[56:59], s77 offen offset:0
    buffer_load_dwordx4 v[44:47], v2, s[56:59], s77 offen offset:1024
    s_add_u32 s77, s76, s74
    buffer_load_dwordx4 v[48:51], v2, s[52:55], s77 offen offset:0
    buffer_load_dwordx4 v[52:55], v2, s[52:55], s77 offen offset:1024
    s_add_u32 s77, s76, s75
    buffer_load_dwordx4 v[56:59], v2, s[52:55], s77 offen offset:0
    buffer_load_dwordx4 v[60:63], v2, s[52:55], s77 offen offset:1024
    s_waitcnt vmcnt(41)
    v_mfma_f32_32x32x16_bf16 v[192:207], v[64:67], v[80:83], v[192:207]
    v_mfma_f32_32x32x16_bf16 v[208:223], v[72:75], v[80:83], v[208:223]
    v_mfma_f32_32x32x16_bf16 v[224:239], v[64:67], v[88:91], v[224:239]
    v_mfma_f32_32x32x16_bf16 v[240:255], v[72:75], v[88:91], v[240:255]
    v_mfma_f32_32x32x16_bf16 v[192:207], v[68:71], v[84:87], v[192:207]
    v_mfma_f32_32x32x16_bf16 v[208:223], v[76:79], v[84:87], v[208:223]
    v_mfma_f32_32x32x16_bf16 v[224:239], v[68:71], v[92:95], v[224:239]
    v_mfma_f32_32x32x16_bf16 v[240:255], v[76:79], v[92:95], v[240:255]
    s_add_u32 s76, s49, 20
    s_min_u32 s76, s76, 42
    s_lshl_b32 s76, s76, 11
    s_add_u32 s77, s76, s72
    buffer_load_dwordx4 v[64:67], v2, s[56:59], s77 offen offset:0
    buffer_load_dwordx4 v[68:71], v2, s[56:59], s77 offen offset:1024
    s_add_u32 s77, s76, s73
    buffer_load_dwordx4 v[72:75], v2, s[56:59], s77 offen offset:0
    buffer_load_dwordx4 v[76:79], v2, s[56:59], s77 offen offset:1024
    s_add_u32 s77, s76, s74
    buffer_load_dwordx4 v[80:83], v2, s[52:55], s77 offen offset:0
    buffer_load_dwordx4 v[84:87], v2, s[52:55], s77 offen offset:1024
    s_add_u32 s77, s76, s75
    buffer_load_dwordx4 v[88:91], v2, s[52:55], s77 offen offset:0
    buffer_load_dwordx4 v[92:95], v2, s[52:55], s77 offen offset:1024
    s_waitcnt vmcnt(41)
    v_mfma_f32_32x32x16_bf16 v[192:207], v[96:99], v[112:115], v[192:207]
    v_mfma_f32_32x32x16_bf16 v[208:223], v[104:107], v[112:115], v[208:223]
    v_mfma_f32_32x32x16_bf16 v[224:239], v[96:99], v[120:123], v[224:239]
    v_mfma_f32_32x32x16_bf16 v[240:255], v[104:107], v[120:123], v[240:255]
    v_mfma_f32_32x32x16_bf16 v[192:207], v[100:103], v[116:119], v[192:207]
    v_mfma_f32_32x32x16_bf16 v[208:223], v[108:111], v[116:119], v[208:223]
    v_mfma_f32_32x32x16_bf16 v[224:239], v[100:103], v[124:127], v[224:239]
    v_mfma_f32_32x32x16_bf16 v[240:255], v[108:111], v[124:127], v[240:255]
    s_add_u32 s76, s49, 24
    s_min_u32 s76, s76, 42
    s_lshl_b32 s76, s76, 11
    s_add_u32 s77, s76, s72
    buffer_load_dwordx4 v[96:99], v2, s[56:59], s77 offen offset:0
    buffer_load_dwordx4 v[100:103], v2, s[56:59], s77 offen offset:1024
    s_add_u32 s77, s76, s73
    buffer_load_dwordx4 v[104:107], v2, s[56:59], s77 offen offset:0
    buffer_load_dwordx4 v[108:111], v2, s[56:59], s77 offen offset:1024
    s_add_u32 s77, s76, s74
    buffer_load_dwordx4 v[112:115], v2, s[52:55], s77 offen offset:0
    buffer_load_dwordx4 v[116:119], v2, s[52:55], s77 offen offset:1024
    s_add_u32 s77, s76, s75
    buffer_load_dwordx4 v[120:123], v2, s[52:55], s77 offen offset:0
    buffer_load_dwordx4 v[124:127], v2, s[52:55], s77 offen offset:1024
    s_waitcnt vmcnt(41)
    v_mfma_f32_32x32x16_bf16 v[192:207], v[128:131], v[144:147], v[192:207]
    v_mfma_f32_32x32x16_bf16 v[208:223], v[136:139], v[144:147], v[208:223]
    v_mfma_f32_32x32x16_bf16 v[224:239], v[128:131], v[152:155], v[224:239]
    v_mfma_f32_32x32x16_bf16 v[240:255], v[136:139], v[152:155], v[240:255]
    v_mfma_f32_32x32x16_bf16 v[192:207], v[132:135], v[148:151], v[192:207]
    v_mfma_f32_32x32x16_bf16 v[208:223], v[140:143], v[148:151], v[208:223]
    v_mfma_f32_32x32x16_bf16 v[224:239], v[132:135], v[156:159], v[224:239]
    v_mfma_f32_32x32x16_bf16 v[240:255], v[140:143], v[156:159], v[240:255]
    s_add_u32 s76, s49, 28
    s_min_u32 s76, s76, 42
    s_lshl_b32 s76, s76, 11
    s_add_u32 s77, s76, s72
    buffer_load_dwordx4 v[128:131], v2, s[56:59], s77 offen offset:0
    buffer_load_dwordx4 v[132:135], v2, s[56:59], s77 offen offset:1024
    s_add_u32 s77, s76, s73
    buffer_load_dwordx4 v[136:139], v2, s[56:59], s77 offen offset:0
    buffer_load_dwordx4 v[140:143], v2, s[56:59], s77 offen offset:1024
    s_add_u32 s77, s76, s74
    buffer_load_dwordx4 v[144:147], v2, s[52:55], s77 offen offset:0
    buffer_load_dwordx4 v[148:151], v2, s[52:55], s77 offen offset:1024
    s_add_u32 s77, s76, s75
    buffer_load_dwordx4 v[152:155], v2, s[52:55], s77 offen offset:0
    buffer_load_dwordx4 v[156:159], v2, s[52:55], s77 offen offset:1024
    s_waitcnt vmcnt(24)
    v_mfma_f32_32x32x16_bf16 v[192:207], v[32:35], v[48:51], v[192:207]
    v_mfma_f32_32x32x16_bf16 v[208:223], v[40:43], v[48:51], v[208:223]
    v_mfma_f32_32x32x16_bf16 v[224:239], v[32:35], v[56:59], v[224:239]
    v_mfma_f32_32x32x16_bf16 v[240:255], v[40:43], v[56:59], v[240:255]
    v_mfma_f32_32x32x16_bf16 v[192:207], v[36:39], v[52:55], v[192:207]
    v_mfma_f32_32x32x16_bf16 v[208:223], v[44:47], v[52:55], v[208:223]
    v_mfma_f32_32x32x16_bf16 v[224:239], v[36:39], v[60:63], v[224:239]
    v_mfma_f32_32x32x16_bf16 v[240:255], v[44:47], v[60:63], v[240:255]
    s_add_u32 s76, s49, 32
    s_min_u32 s76, s76, 42
    s_lshl_b32 s76, s76, 11
    s_add_u32 s77, s76, s72
    buffer_load_dwordx4 v[32:35], v2, s[56:59], s77 offen offset:0
    buffer_load_dwordx4 v[36:39], v2, s[56:59], s77 offen offset:1024
    s_add_u32 s77, s76, s73
    buffer_load_dwordx4 v[40:43], v2, s[56:59], s77 offen offset:0
    buffer_load_dwordx4 v[44:47], v2, s[56:59], s77 offen offset:1024
    s_add_u32 s77, s76, s74
    buffer_load_dwordx4 v[48:51], v2, s[52:55], s77 offen offset:0
    buffer_load_dwordx4 v[52:55], v2, s[52:55], s77 offen offset:1024
    s_add_u32 s77, s76, s75
    buffer_load_dwordx4 v[56:59], v2, s[52:55], s77 offen offset:0
    buffer_load_dwordx4 v[60:63], v2, s[52:55], s77 offen offset:1024
    s_waitcnt vmcnt(24)
    v_mfma_f32_32x32x16_bf16 v[192:207], v[64:67], v[80:83], v[192:207]
    v_mfma_f32_32x32x16_bf16 v[208:223], v[72:75], v[80:83], v[208:223]
    v_mfma_f32_32x32x16_bf16 v[224:239], v[64:67], v[88:91], v[224:239]
    v_mfma_f32_32x32x16_bf16 v[240:255], v[72:75], v[88:91], v[240:255]
    v_mfma_f32_32x32x16_bf16 v[192:207], v[68:71], v[84:87], v[192:207]
    v_mfma_f32_32x32x16_bf16 v[208:223], v[76:79], v[84:87], v[208:223]
    v_mfma_f32_32x32x16_bf16 v[224:239], v[68:71], v[92:95], v[224:239]
    v_mfma_f32_32x32x16_bf16 v[240:255], v[76:79], v[92:95], v[240:255]
    s_add_u32 s76, s49, 36
    s_min_u32 s76, s76, 42
    s_lshl_b32 s76, s76, 11
    s_add_u32 s77, s76, s72
    buffer_load_dwordx4 v[64:67], v2, s[56:59], s77 offen offset:0
    buffer_load_dwordx4 v[68:71], v2, s[56:59], s77 offen offset:1024
    s_add_u32 s77, s76, s73
    buffer_load_dwordx4 v[72:75], v2, s[56:59], s77 offen offset:0
    buffer_load_dwordx4 v[76:79], v2, s[56:59], s77 offen offset:1024
    s_add_u32 s77, s76, s74
    buffer_load_dwordx4 v[80:83], v2, s[52:55], s77 offen offset:0
    buffer_load_dwordx4 v[84:87], v2, s[52:55], s77 offen offset:1024
    s_add_u32 s77, s76, s75
    buffer_load_dwordx4 v[88:91], v2, s[52:55], s77 offen offset:0
    buffer_load_dwordx4 v[92:95], v2, s[52:55], s77 offen offset:1024
    s_waitcnt vmcnt(24)
    v_mfma_f32_32x32x16_bf16 v[192:207], v[96:99], v[112:115], v[192:207]
    v_mfma_f32_32x32x16_bf16 v[208:223], v[104:107], v[112:115], v[208:223]
    v_mfma_f32_32x32x16_bf16 v[224:239], v[96:99], v[120:123], v[224:239]
    v_mfma_f32_32x32x16_bf16 v[240:255], v[104:107], v[120:123], v[240:255]
    v_mfma_f32_32x32x16_bf16 v[192:207], v[100:103], v[116:119], v[192:207]
    v_mfma_f32_32x32x16_bf16 v[208:223], v[108:111], v[116:119], v[208:223]
    v_mfma_f32_32x32x16_bf16 v[224:239], v[100:103], v[124:127], v[224:239]
    v_mfma_f32_32x32x16_bf16 v[240:255], v[108:111], v[124:127], v[240:255]
    s_add_u32 s76, s49, 40
    s_min_u32 s76, s76, 42
    s_lshl_b32 s76, s76, 11
    s_add_u32 s77, s76, s72
    buffer_load_dwordx4 v[96:99], v2, s[56:59], s77 offen offset:0
    buffer_load_dwordx4 v[100:103], v2, s[56:59], s77 offen offset:1024
    s_add_u32 s77, s76, s73
    buffer_load_dwordx4 v[104:107], v2, s[56:59], s77 offen offset:0
    buffer_load_dwordx4 v[108:111], v2, s[56:59], s77 offen offset:1024
    s_add_u32 s77, s76, s74
    buffer_load_dwordx4 v[112:115], v2, s[52:55], s77 offen offset:0
    buffer_load_dwordx4 v[116:119], v2, s[52:55], s77 offen offset:1024
    s_add_u32 s77, s76, s75
    buffer_load_dwordx4 v[120:123], v2, s[52:55], s77 offen offset:0
    buffer_load_dwordx4 v[124:127], v2, s[52:55], s77 offen offset:1024
    s_waitcnt vmcnt(24)
    v_mfma_f32_32x32x16_bf16 v[192:207], v[128:131], v[144:147], v[192:207]
    v_mfma_f32_32x32x16_bf16 v[208:223], v[136:139], v[144:147], v[208:223]
    v_mfma_f32_32x32x16_bf16 v[224:239], v[128:131], v[152:155], v[224:239]
    v_mfma_f32_32x32x16_bf16 v[240:255], v[136:139], v[152:155], v[240:255]
    v_mfma_f32_32x32x16_bf16 v[192:207], v[132:135], v[148:151], v[192:207]
    v_mfma_f32_32x32x16_bf16 v[208:223], v[140:143], v[148:151], v[208:223]
    v_mfma_f32_32x32x16_bf16 v[224:239], v[132:135], v[156:159], v[224:239]
    v_mfma_f32_32x32x16_bf16 v[240:255], v[140:143], v[156:159], v[240:255]
    s_waitcnt vmcnt(16)
    v_mfma_f32_32x32x16_bf16 v[192:207], v[32:35], v[48:51], v[192:207]
    v_mfma_f32_32x32x16_bf16 v[208:223], v[40:43], v[48:51], v[208:223]
    v_mfma_f32_32x32x16_bf16 v[224:239], v[32:35], v[56:59], v[224:239]
    v_mfma_f32_32x32x16_bf16 v[240:255], v[40:43], v[56:59], v[240:255]
    v_mfma_f32_32x32x16_bf16 v[192:207], v[36:39], v[52:55], v[192:207]
    v_mfma_f32_32x32x16_bf16 v[208:223], v[44:47], v[52:55], v[208:223]
    v_mfma_f32_32x32x16_bf16 v[224:239], v[36:39], v[60:63], v[224:239]
    v_mfma_f32_32x32x16_bf16 v[240:255], v[44:47], v[60:63], v[240:255]
    s_waitcnt vmcnt(8)
    v_mfma_f32_32x32x16_bf16 v[192:207], v[64:67], v[80:83], v[192:207]
    v_mfma_f32_32x32x16_bf16 v[208:223], v[72:75], v[80:83], v[208:223]
    v_mfma_f32_32x32x16_bf16 v[224:239], v[64:67], v[88:91], v[224:239]
    v_mfma_f32_32x32x16_bf16 v[240:255], v[72:75], v[88:91], v[240:255]
    v_mfma_f32_32x32x16_bf16 v[192:207], v[68:71], v[84:87], v[192:207]
    v_mfma_f32_32x32x16_bf16 v[208:223], v[76:79], v[84:87], v[208:223]
    v_mfma_f32_32x32x16_bf16 v[224:239], v[68:71], v[92:95], v[224:239]
    v_mfma_f32_32x32x16_bf16 v[240:255], v[76:79], v[92:95], v[240:255]
    s_waitcnt vmcnt(0)
    s_cmp_eq_u32 s49, 3
    s_cbranch_scc1 K2_RED
    v_mfma_f32_32x32x16_bf16 v[192:207], v[96:99], v[112:115], v[192:207]
    v_mfma_f32_32x32x16_bf16 v[208:223], v[104:107], v[112:115], v[208:223]
    v_mfma_f32_32x32x16_bf16 v[224:239], v[96:99], v[120:123], v[224:239]
    v_mfma_f32_32x32x16_bf16 v[240:255], v[104:107], v[120:123], v[240:255]
    v_mfma_f32_32x32x16_bf16 v[192:207], v[100:103], v[116:119], v[192:207]
    v_mfma_f32_32x32x16_bf16 v[208:223], v[108:111], v[116:119], v[208:223]
    v_mfma_f32_32x32x16_bf16 v[224:239], v[100:103], v[124:127], v[224:239]
    v_mfma_f32_32x32x16_bf16 v[240:255], v[108:111], v[124:127], v[240:255]
K2_RED:
    s_nop 15
    s_lshl_b32 s76, s49, 14
    v_add_u32 v24, s76, v2
    ds_write_b128 v24, v[192:195] offset:0
    ds_write_b128 v24, v[196:199] offset:1024
    ds_write_b128 v24, v[200:203] offset:2048
    ds_write_b128 v24, v[204:207] offset:3072
    ds_write_b128 v24, v[208:211] offset:4096
    ds_write_b128 v24, v[212:215] offset:5120
    ds_write_b128 v24, v[216:219] offset:6144
    ds_write_b128 v24, v[220:223] offset:7168
    ds_write_b128 v24, v[224:227] offset:8192
    ds_write_b128 v24, v[228:231] offset:9216
    ds_write_b128 v24, v[232:235] offset:10240
    ds_write_b128 v24, v[236:239] offset:11264
    ds_write_b128 v24, v[240:243] offset:12288
    ds_write_b128 v24, v[244:247] offset:13312
    ds_write_b128 v24, v[248:251] offset:14336
    ds_write_b128 v24, v[252:255] offset:15360
    s_waitcnt lgkmcnt(0)
    s_barrier
    s_lshl_b32 s76, s49, 12
    v_add_u32 v24, s76, v2
    ds_read_b128 v[64:67], v24 offset:0
    ds_read_b128 v[80:83], v24 offset:16384
    ds_read_b128 v[96:99], v24 offset:32768
    ds_read_b128 v[112:115], v24 offset:49152
    ds_read_b128 v[68:71], v24 offset:1024
    ds_read_b128 v[84:87], v24 offset:17408
    ds_read_b128 v[100:103], v24 offset:33792
    ds_read_b128 v[116:119], v24 offset:50176
    ds_read_b128 v[72:75], v24 offset:2048
    ds_read_b128 v[88:91], v24 offset:18432
    ds_read_b128 v[104:107], v24 offset:34816
    ds_read_b128 v[120:123], v24 offset:51200
    ds_read_b128 v[76:79], v24 offset:3072
    ds_read_b128 v[92:95], v24 offset:19456
    ds_read_b128 v[108:111], v24 offset:35840
    ds_read_b128 v[124:127], v24 offset:52224
    s_waitcnt vmcnt(0)
    v_sub_f32 v26, 1.0, v7
    v_cvt_pk_bf16_f32 v26, v26, v26
    v_lshlrev_b32 v26, 16, v26
    v_mov_b32 v27, v26
    v_mov_b32 v28, v7
    v_mov_b32 v29, v7
    s_waitcnt lgkmcnt(12)
    v_pk_add_f32 v[64:65], v[64:65], v[80:81]
    v_pk_add_f32 v[96:97], v[96:97], v[112:113]
    v_pk_add_f32 v[64:65], v[64:65], v[96:97]
    v_cvt_pk_bf16_f32 v40, v64, v65
    v_and_b32 v41, 0xffff0000, v40
    v_lshlrev_b32 v40, 16, v40
    v_pk_mul_f32 v[40:41], v[40:41], v[26:27]
    v_cvt_pk_bf16_f32 v40, v40, v41
    v_lshlrev_b32 v42, 16, v8
    v_lshlrev_b32 v43, 16, v9
    v_pk_mul_f32 v[42:43], v[42:43], v[28:29]
    v_cvt_pk_bf16_f32 v42, v42, v43
    v_and_b32 v41, 0xffff0000, v40
    v_lshlrev_b32 v40, 16, v40
    v_and_b32 v43, 0xffff0000, v42
    v_lshlrev_b32 v42, 16, v42
    v_pk_add_f32 v[40:41], v[40:41], v[42:43]
    v_cvt_pk_bf16_f32 v30, v40, v41
    v_pk_add_f32 v[66:67], v[66:67], v[82:83]
    v_pk_add_f32 v[98:99], v[98:99], v[114:115]
    v_pk_add_f32 v[66:67], v[66:67], v[98:99]
    v_cvt_pk_bf16_f32 v40, v66, v67
    v_and_b32 v41, 0xffff0000, v40
    v_lshlrev_b32 v40, 16, v40
    v_pk_mul_f32 v[40:41], v[40:41], v[26:27]
    v_cvt_pk_bf16_f32 v40, v40, v41
    v_lshlrev_b32 v42, 16, v10
    v_lshlrev_b32 v43, 16, v11
    v_pk_mul_f32 v[42:43], v[42:43], v[28:29]
    v_cvt_pk_bf16_f32 v42, v42, v43
    v_and_b32 v41, 0xffff0000, v40
    v_lshlrev_b32 v40, 16, v40
    v_and_b32 v43, 0xffff0000, v42
    v_lshlrev_b32 v42, 16, v42
    v_pk_add_f32 v[40:41], v[40:41], v[42:43]
    v_cvt_pk_bf16_f32 v31, v40, v41
    buffer_store_dwordx2 v[30:31], v4, s[68:71], 0 offen offset:0
    s_nop 1
    s_waitcnt lgkmcnt(8)
    v_pk_add_f32 v[68:69], v[68:69], v[84:85]
    v_pk_add_f32 v[100:101], v[100:101], v[116:117]
    v_pk_add_f32 v[68:69], v[68:69], v[100:101]
    v_cvt_pk_bf16_f32 v40, v68, v69
    v_and_b32 v41, 0xffff0000, v40
    v_lshlrev_b32 v40, 16, v40
    v_pk_mul_f32 v[40:41], v[40:41], v[26:27]
    v_cvt_pk_bf16_f32 v40, v40, v41
    v_lshlrev_b32 v42, 16, v12
    v_lshlrev_b32 v43, 16, v13
    v_pk_mul_f32 v[42:43], v[42:43], v[28:29]
    v_cvt_pk_bf16_f32 v42, v42, v43
    v_and_b32 v41, 0xffff0000, v40
    v_lshlrev_b32 v40, 16, v40
    v_and_b32 v43, 0xffff0000, v42
    v_lshlrev_b32 v42, 16, v42
    v_pk_add_f32 v[40:41], v[40:41], v[42:43]
    v_cvt_pk_bf16_f32 v30, v40, v41
    v_pk_add_f32 v[70:71], v[70:71], v[86:87]
    v_pk_add_f32 v[102:103], v[102:103], v[118:119]
    v_pk_add_f32 v[70:71], v[70:71], v[102:103]
    v_cvt_pk_bf16_f32 v40, v70, v71
    v_and_b32 v41, 0xffff0000, v40
    v_lshlrev_b32 v40, 16, v40
    v_pk_mul_f32 v[40:41], v[40:41], v[26:27]
    v_cvt_pk_bf16_f32 v40, v40, v41
    v_lshlrev_b32 v42, 16, v14
    v_lshlrev_b32 v43, 16, v15
    v_pk_mul_f32 v[42:43], v[42:43], v[28:29]
    v_cvt_pk_bf16_f32 v42, v42, v43
    v_and_b32 v41, 0xffff0000, v40
    v_lshlrev_b32 v40, 16, v40
    v_and_b32 v43, 0xffff0000, v42
    v_lshlrev_b32 v42, 16, v42
    v_pk_add_f32 v[40:41], v[40:41], v[42:43]
    v_cvt_pk_bf16_f32 v31, v40, v41
    buffer_store_dwordx2 v[30:31], v4, s[68:71], 0 offen offset:16
    s_nop 1
    s_waitcnt lgkmcnt(4)
    v_pk_add_f32 v[72:73], v[72:73], v[88:89]
    v_pk_add_f32 v[104:105], v[104:105], v[120:121]
    v_pk_add_f32 v[72:73], v[72:73], v[104:105]
    v_cvt_pk_bf16_f32 v40, v72, v73
    v_and_b32 v41, 0xffff0000, v40
    v_lshlrev_b32 v40, 16, v40
    v_pk_mul_f32 v[40:41], v[40:41], v[26:27]
    v_cvt_pk_bf16_f32 v40, v40, v41
    v_lshlrev_b32 v42, 16, v16
    v_lshlrev_b32 v43, 16, v17
    v_pk_mul_f32 v[42:43], v[42:43], v[28:29]
    v_cvt_pk_bf16_f32 v42, v42, v43
    v_and_b32 v41, 0xffff0000, v40
    v_lshlrev_b32 v40, 16, v40
    v_and_b32 v43, 0xffff0000, v42
    v_lshlrev_b32 v42, 16, v42
    v_pk_add_f32 v[40:41], v[40:41], v[42:43]
    v_cvt_pk_bf16_f32 v30, v40, v41
    v_pk_add_f32 v[74:75], v[74:75], v[90:91]
    v_pk_add_f32 v[106:107], v[106:107], v[122:123]
    v_pk_add_f32 v[74:75], v[74:75], v[106:107]
    v_cvt_pk_bf16_f32 v40, v74, v75
    v_and_b32 v41, 0xffff0000, v40
    v_lshlrev_b32 v40, 16, v40
    v_pk_mul_f32 v[40:41], v[40:41], v[26:27]
    v_cvt_pk_bf16_f32 v40, v40, v41
    v_lshlrev_b32 v42, 16, v18
    v_lshlrev_b32 v43, 16, v19
    v_pk_mul_f32 v[42:43], v[42:43], v[28:29]
    v_cvt_pk_bf16_f32 v42, v42, v43
    v_and_b32 v41, 0xffff0000, v40
    v_lshlrev_b32 v40, 16, v40
    v_and_b32 v43, 0xffff0000, v42
    v_lshlrev_b32 v42, 16, v42
    v_pk_add_f32 v[40:41], v[40:41], v[42:43]
    v_cvt_pk_bf16_f32 v31, v40, v41
    buffer_store_dwordx2 v[30:31], v4, s[68:71], 0 offen offset:32
    s_nop 1
    s_waitcnt lgkmcnt(0)
    v_pk_add_f32 v[76:77], v[76:77], v[92:93]
    v_pk_add_f32 v[108:109], v[108:109], v[124:125]
    v_pk_add_f32 v[76:77], v[76:77], v[108:109]
    v_cvt_pk_bf16_f32 v40, v76, v77
    v_and_b32 v41, 0xffff0000, v40
    v_lshlrev_b32 v40, 16, v40
    v_pk_mul_f32 v[40:41], v[40:41], v[26:27]
    v_cvt_pk_bf16_f32 v40, v40, v41
    v_lshlrev_b32 v42, 16, v20
    v_lshlrev_b32 v43, 16, v21
    v_pk_mul_f32 v[42:43], v[42:43], v[28:29]
    v_cvt_pk_bf16_f32 v42, v42, v43
    v_and_b32 v41, 0xffff0000, v40
    v_lshlrev_b32 v40, 16, v40
    v_and_b32 v43, 0xffff0000, v42
    v_lshlrev_b32 v42, 16, v42
    v_pk_add_f32 v[40:41], v[40:41], v[42:43]
    v_cvt_pk_bf16_f32 v30, v40, v41
    v_pk_add_f32 v[78:79], v[78:79], v[94:95]
    v_pk_add_f32 v[110:111], v[110:111], v[126:127]
    v_pk_add_f32 v[78:79], v[78:79], v[110:111]
    v_cvt_pk_bf16_f32 v40, v78, v79
    v_and_b32 v41, 0xffff0000, v40
    v_lshlrev_b32 v40, 16, v40
    v_pk_mul_f32 v[40:41], v[40:41], v[26:27]
    v_cvt_pk_bf16_f32 v40, v40, v41
    v_lshlrev_b32 v42, 16, v22
    v_lshlrev_b32 v43, 16, v23
    v_pk_mul_f32 v[42:43], v[42:43], v[28:29]
    v_cvt_pk_bf16_f32 v42, v42, v43
    v_and_b32 v41, 0xffff0000, v40
    v_lshlrev_b32 v40, 16, v40
    v_and_b32 v43, 0xffff0000, v42
    v_lshlrev_b32 v42, 16, v42
    v_pk_add_f32 v[40:41], v[40:41], v[42:43]
    v_cvt_pk_bf16_f32 v31, v40, v41
    buffer_store_dwordx2 v[30:31], v4, s[68:71], 0 offen offset:48
    s_nop 1
K2_EXIT:
    s_endpgm
.section .rodata,"a"
.p2align 6
.amdhsa_kernel k1_kernel
  .amdhsa_next_free_vgpr 256
  .amdhsa_next_free_sgpr 102
  .amdhsa_accum_offset 256
  .amdhsa_group_segment_fixed_size 0
  .amdhsa_kernarg_size 120
  .amdhsa_user_sgpr_count 2
  .amdhsa_user_sgpr_kernarg_segment_ptr 1
  .amdhsa_system_sgpr_workgroup_id_x 1
.end_amdhsa_kernel
.p2align 6
.amdhsa_kernel k2_kernel
  .amdhsa_next_free_vgpr 256
  .amdhsa_next_free_sgpr 102
  .amdhsa_accum_offset 256
  .amdhsa_group_segment_fixed_size 0
  .amdhsa_kernarg_size 120
  .amdhsa_user_sgpr_count 2
  .amdhsa_user_sgpr_kernarg_segment_ptr 1
  .amdhsa_system_sgpr_workgroup_id_x 1
.end_amdhsa_kernel
```
